```python
import torch

def _softmax(x, axis=-1):
    return torch.softmax(x, dim=axis)
def _gelu(x):
    return torch.nn.functional.gelu(x, approximate="tanh")
def _silu(x):
    return torch.nn.functional.silu(x)
def _sigmoid(x):
    return torch.sigmoid(x)
def _layernorm(x, axis=-1, eps=1e-5):
    m = x.mean(dim=axis, keepdim=True)
    v = x.var(dim=axis, keepdim=True, unbiased=False)
    return (x - m) / torch.sqrt(v + eps)
def _scatter_add(tgt, idx, src, axis=0):
    return tgt.clone().index_add_(axis, idx, src)
def _segment_sum(src, seg, n):
    out = torch.zeros((n,) + src.shape[1:], dtype=src.dtype)
    return out.index_add_(0, seg, src)
def _pad(x, pw):
    flat = tuple(v for pair in reversed(pw) for v in pair)
    return torch.nn.functional.pad(x, flat)

kernel_name = 'concat_heads__mha_block_cached__gqa_block_cached__near_ridge'

def setup_inputs():

    _w = (lambda a: (lambda t: t.to(torch.bfloat16) if t.is_floating_point() else t)(torch.as_tensor(a)))
    def _A_setup():
        B, Sq, D = 16, 48, 1024
        H, Sk, Dh = 32, 48, 128
        return {
            "x": _w((lambda *s: torch.randn(*s, dtype=torch.bfloat16) * 0.8)(B, Sq, D)),
            "k_cache": _w((lambda *s: torch.randn(*s, dtype=torch.bfloat16) * 0.8)(B, H, Sk, Dh)),
            "v_cache": _w((lambda *s: torch.randn(*s, dtype=torch.bfloat16) * 0.05)(B, H, Sk, Dh)),
            "wq": _w((lambda *s: torch.randn(*s, dtype=torch.bfloat16) * 0.8)(D, H * Dh) * (D ** -0.5)),
            "wo": _w((lambda *s: torch.randn(*s, dtype=torch.bfloat16) * 0.05)(H * Dh, D) * ((H * Dh) ** -0.5)),
        }
    _A_in = _A_setup()

    def _B_setup():
        B, Sq, D = 16, 48, 1024
        Hq, Hkv, Sk, Dh = 32, 32, 48, 128
        assert Hq % Hkv == 0, (Hq, Hkv)
        return {
            "x": _w((lambda *s: torch.randn(*s, dtype=torch.bfloat16) * 0.8)(B, Sq, D)),
            "k_cache": _w((lambda *s: torch.randn(*s, dtype=torch.bfloat16) * 0.8)(B, Hkv, Sk, Dh)),
            "v_cache": _w((lambda *s: torch.randn(*s, dtype=torch.bfloat16) * 0.05)(B, Hkv, Sk, Dh)),
            "wq": _w((lambda *s: torch.randn(*s, dtype=torch.bfloat16) * 0.8)(D, Hq * Dh) * (D ** -0.5)),
            "wo": _w((lambda *s: torch.randn(*s, dtype=torch.bfloat16) * 0.05)(Hq * Dh, D) * ((Hq * Dh) ** -0.5)),
        }
    _B_in = _B_setup()

    return {
        "A_x": _A_in["x"],
        "A_k_cache": _A_in["k_cache"],
        "A_v_cache": _A_in["v_cache"],
        "A_wq": _A_in["wq"],
        "A_wo": _A_in["wo"],
        "B_x": _B_in["x"],
        "B_k_cache": _B_in["k_cache"],
        "B_v_cache": _B_in["v_cache"],
        "B_wq": _B_in["wq"],
        "B_wo": _B_in["wo"],
    }

def reference(A_x, A_k_cache, A_v_cache, A_wq, A_wo, B_x, B_k_cache, B_v_cache, B_wq, B_wo):
    def _A_ref(x, k_cache, v_cache, wq, wo):
        B, Sq, D = x.shape
        H, Dh = 32, 128
        q = (lambda x, *d: x.permute(*d))((x @ wq).reshape(B, Sq, H, Dh), 0, 2, 1, 3)
        scores = torch.einsum("bhqd,bhkd->bhqk", q, k_cache) * (Dh ** -0.5)
        p = _softmax(scores, axis=-1)
        o = torch.einsum("bhqk,bhkd->bhqd", p, v_cache)
        return (lambda x, *d: x.permute(*d))(o, 0, 2, 1, 3).reshape(B, Sq, H * Dh) @ wo

    def _B_ref(x, k_cache, v_cache, wq, wo):
        B, Sq, D = x.shape
        Hq, Dh = 32, 128
        Hkv = k_cache.shape[1]
        rep = Hq // Hkv
        q = (lambda x, *d: x.permute(*d))((x @ wq).reshape(B, Sq, Hq, Dh), 0, 2, 1, 3)
        k = (lambda x, n, axis: torch.repeat_interleave(x, n, dim=axis))(k_cache, rep, axis=1)
        v = (lambda x, n, axis: torch.repeat_interleave(x, n, dim=axis))(v_cache, rep, axis=1)
        scores = torch.einsum("bhqd,bhkd->bhqk", q, k) * (Dh ** -0.5)
        p = _softmax(scores, axis=-1)
        o = torch.einsum("bhqk,bhkd->bhqd", p, v)
        return (lambda x, *d: x.permute(*d))(o, 0, 2, 1, 3).reshape(B, Sq, Hq * Dh) @ wo

    a = _A_ref(A_x, A_k_cache, A_v_cache, A_wq, A_wo)
    b = _B_ref(B_x, B_k_cache, B_v_cache, B_wq, B_wo)
    return torch.concatenate([a, b], axis=-1)
```

```asm
; @launch grid=(256,1,1) block=(256,1,1) lds=163840
.amdgcn_target "amdgcn-amd-amdhsa--gfx950"
.text
.globl concat_heads__mha_block_cached__gqa_block_cached__near_ridge_kernel
.p2align 8
.type concat_heads__mha_block_cached__gqa_block_cached__near_ridge_kernel,@function
concat_heads__mha_block_cached__gqa_block_cached__near_ridge_kernel:
s_cmp_ge_u32 s2, 256
s_cbranch_scc1 L_end
s_and_b32 s3, s2, 7
s_lshr_b32 s28, s3, 2
s_and_b32 s27, s3, 3
s_lshr_b32 s3, s2, 3
s_and_b32 s25, s3, 7
s_lshr_b32 s26, s3, 3
s_mul_i32 s3, s28, 40
s_add_u32 s36, s0, s3
s_addc_u32 s37, s1, 0
s_load_dwordx2 s[4:5], s[36:37], 0
s_load_dwordx2 s[8:9], s[36:37], 24
s_load_dwordx2 s[12:13], s[36:37], 8
s_load_dwordx2 s[16:17], s[36:37], 16
s_load_dwordx2 s[40:41], s[36:37], 32
s_load_dwordx2 s[20:21], s[0:1], 96
s_load_dwordx2 s[44:45], s[0:1], 80
s_load_dwordx2 s[48:49], s[0:1], 88
v_and_b32 v1, 63, v0
v_lshrrev_b32 v2, 6, v0
v_lshrrev_b32 v3, 4, v1
v_readfirstlane_b32 s24, v2
v_and_b32 v4, 15, v1
s_mov_b32 s29, 0
s_lshl_b32 s34, s27, 3
s_add_u32 s34, s34, s25
s_lshl_b32 s35, s34, 8
s_lshl_b32 s32, s24, 12
s_mul_i32 s33, s24, 28672
s_add_u32 s33, s33, 49152
s_lshl_b32 s3, s24, 4
v_or_b32 v5, 0, v3
v_lshlrev_b32 v5, 1, v5
v_xor_b32 v5, v5, v4
v_lshlrev_b32 v5, 4, v5
v_add_u32 v6, s3, v3
v_add_u32 v6, 0, v6
v_lshlrev_b32 v6, 13, v6
v_add3_u32 v5, v5, v6, s35
v_subrev_u32 v8, 0, v5
v_or_b32 v5, 0, v3
v_lshlrev_b32 v5, 1, v5
v_xor_b32 v5, v5, v4
v_lshlrev_b32 v5, 4, v5
v_add_u32 v6, s3, v3
v_add_u32 v6, 4, v6
v_lshlrev_b32 v6, 13, v6
v_add3_u32 v5, v5, v6, s35
v_subrev_u32 v9, 1024, v5
v_or_b32 v5, 4, v3
v_lshlrev_b32 v5, 1, v5
v_xor_b32 v5, v5, v4
v_lshlrev_b32 v5, 4, v5
v_add_u32 v6, s3, v3
v_add_u32 v6, 8, v6
v_lshlrev_b32 v6, 13, v6
v_add3_u32 v5, v5, v6, s35
v_subrev_u32 v10, 2048, v5
v_or_b32 v5, 4, v3
v_lshlrev_b32 v5, 1, v5
v_xor_b32 v5, v5, v4
v_lshlrev_b32 v5, 4, v5
v_add_u32 v6, s3, v3
v_add_u32 v6, 12, v6
v_lshlrev_b32 v6, 13, v6
v_add3_u32 v5, v5, v6, s35
v_subrev_u32 v11, 3072, v5
s_mul_i32 s3, s26, 192
s_mul_i32 s38, s24, 48
s_add_u32 s38, s38, s3
v_lshrrev_b32 v6, 3, v1
v_and_b32 v7, 7, v1
v_add_u32 v5, 0, v3
v_xor_b32 v5, v5, v7
v_lshlrev_b32 v5, 4, v5
v_add_u32 v2, 0, v6
v_add_u32 v2, s38, v2
v_lshlrev_b32 v2, 11, v2
v_add_u32 v5, v5, v2
v_subrev_u32 v12, 0, v5
v_add_u32 v5, 4, v3
v_xor_b32 v5, v5, v7
v_lshlrev_b32 v5, 4, v5
v_add_u32 v2, 8, v6
v_add_u32 v2, s38, v2
v_lshlrev_b32 v2, 11, v2
v_add_u32 v5, v5, v2
v_subrev_u32 v13, 1024, v5
v_add_u32 v5, 0, v3
v_xor_b32 v5, v5, v7
v_lshlrev_b32 v5, 4, v5
v_add_u32 v2, 16, v6
v_add_u32 v2, s38, v2
v_lshlrev_b32 v2, 11, v2
v_add_u32 v5, v5, v2
v_subrev_u32 v14, 2048, v5
v_add_u32 v5, 4, v3
v_xor_b32 v5, v5, v7
v_lshlrev_b32 v5, 4, v5
v_add_u32 v2, 24, v6
v_add_u32 v2, s38, v2
v_lshlrev_b32 v2, 11, v2
v_add_u32 v5, v5, v2
v_subrev_u32 v15, 3072, v5
v_add_u32 v5, 0, v3
v_xor_b32 v5, v5, v7
v_lshlrev_b32 v5, 4, v5
v_add_u32 v2, 32, v6
v_add_u32 v2, s38, v2
v_lshlrev_b32 v2, 11, v2
v_add_u32 v5, v5, v2
v_subrev_u32 v16, 0, v5
v_add_u32 v5, 4, v3
v_xor_b32 v5, v5, v7
v_lshlrev_b32 v5, 4, v5
v_add_u32 v2, 40, v6
v_add_u32 v2, s38, v2
v_lshlrev_b32 v2, 11, v2
v_add_u32 v5, v5, v2
v_subrev_u32 v17, 1024, v5
s_waitcnt lgkmcnt(0)
s_and_b32 s5, s5, 0xffff
s_mov_b32 s6, 1572864
s_mov_b32 s7, 0x20000
s_and_b32 s9, s9, 0xffff
s_mov_b32 s10, 8388608
s_mov_b32 s11, 0x20000
s_add_u32 s1, s25, s26
s_and_b32 s0, s2, 3
s_add_u32 s55, s0, 0
s_and_b32 s55, s55, 15
s_add_u32 s31, s55, s1
s_and_b32 s31, s31, 3
s_and_b32 s55, s55, 12
s_or_b32 s55, s55, s31
s_lshl_b32 s30, s55, 19
s_lshl_b32 s31, s55, 7
s_add_u32 m0, s32, 0
s_nop 0
buffer_load_dwordx4 v8, s[8:11], s30 offen offset:0 lds
buffer_load_dwordx4 v9, s[8:11], s30 offen offset:1024 lds
buffer_load_dwordx4 v10, s[8:11], s30 offen offset:2048 lds
buffer_load_dwordx4 v11, s[8:11], s30 offen offset:3072 lds
s_add_u32 m0, s33, 6144
s_nop 0
buffer_load_dwordx4 v12, s[4:7], s31 offen offset:0 lds
buffer_load_dwordx4 v13, s[4:7], s31 offen offset:1024 lds
buffer_load_dwordx4 v14, s[4:7], s31 offen offset:2048 lds
buffer_load_dwordx4 v15, s[4:7], s31 offen offset:3072 lds
s_add_u32 m0, s33, 10240
s_nop 0
buffer_load_dwordx4 v16, s[4:7], s31 offen offset:0 lds
buffer_load_dwordx4 v17, s[4:7], s31 offen offset:1024 lds
s_and_b32 s13, s13, 0xffff
s_mov_b32 s14, 6291456
s_mov_b32 s15, 0x20000
s_and_b32 s17, s17, 0xffff
s_mov_b32 s18, 6291456
s_mov_b32 s19, 0x20000
s_and_b32 s41, s41, 0xffff
s_mov_b32 s42, 8388608
s_mov_b32 s43, 0x20000
s_and_b32 s21, s21, 0xffff
s_mov_b32 s22, 223391744
s_mov_b32 s23, 0x20000
s_and_b32 s45, s45, 0xffff
s_mov_b32 s46, 3145728
s_mov_b32 s47, 0x20000
s_and_b32 s49, s49, 0xffff
s_mov_b32 s50, 256
s_mov_b32 s51, 0x20000
v_lshrrev_b32 v5, 2, v4
v_and_b32 v6, 3, v1
v_lshl_add_u32 v7, v3, 3, v5
v_lshlrev_b32 v7, 8, v7
v_lshl_add_u32 v7, v6, 3, v7
v_and_b32 v2, 1, v3
v_lshl_or_b32 v2, v2, 2, v5
v_lshlrev_b32 v2, 5, v2
v_add_u32 v20, v7, v2
v_xor_b32 v21, 32, v20
v_xor_b32 v22, 64, v20
v_xor_b32 v23, 96, v20
v_xor_b32 v24, 128, v20
v_xor_b32 v25, 160, v20
v_xor_b32 v26, 192, v20
v_xor_b32 v27, 224, v20
v_lshrrev_b32 v5, 1, v4
v_xor_b32 v5, v5, v3
v_lshlrev_b32 v5, 4, v5
v_lshl_add_u32 v5, v4, 7, v5
v_add_u32 v28, s33, v5
v_xor_b32 v29, 64, v28
v_add_u32 v5, 0, v3
v_xor_b32 v5, v5, v4
v_lshlrev_b32 v5, 4, v5
v_lshl_add_u32 v30, v3, 8, v5
v_add_u32 v5, 4, v3
v_xor_b32 v5, v5, v4
v_lshlrev_b32 v5, 4, v5
v_lshl_add_u32 v31, v3, 8, v5
v_add_u32 v5, 8, v3
v_xor_b32 v5, v5, v4
v_lshlrev_b32 v5, 4, v5
v_lshl_add_u32 v32, v3, 8, v5
v_add_u32 v5, 12, v3
v_xor_b32 v5, v5, v4
v_lshlrev_b32 v5, 4, v5
v_lshl_add_u32 v33, v3, 8, v5
v_add_u32 v5, 0, v3
v_lshlrev_b32 v5, 1, v5
v_xor_b32 v5, v5, v4
v_lshlrev_b32 v5, 4, v5
v_lshl_add_u32 v34, v3, 8, v5
v_add_u32 v5, 4, v3
v_lshlrev_b32 v5, 1, v5
v_xor_b32 v5, v5, v4
v_lshlrev_b32 v5, 4, v5
v_lshl_add_u32 v35, v3, 8, v5
v_lshrrev_b32 v5, 1, v3
v_xor_b32 v5, v5, v4
v_lshlrev_b32 v5, 4, v5
v_lshl_add_u32 v5, v4, 8, v5
v_and_b32 v6, 1, v3
v_lshl_add_u32 v5, v6, 3, v5
s_add_u32 s3, s33, 18432
v_add_u32 v36, s3, v5
v_xor_b32 v37, 32, v36
v_xor_b32 v38, 64, v36
v_xor_b32 v39, 96, v36
v_xor_b32 v40, 128, v36
v_xor_b32 v41, 160, v36
v_xor_b32 v42, 192, v36
v_xor_b32 v43, 224, v36
v_lshrrev_b32 v5, 2, v4
v_and_b32 v6, 3, v1
v_lshl_add_u32 v7, v3, 2, v5
v_lshlrev_b32 v2, 8, v7
v_lshl_add_u32 v2, v6, 3, v2
v_and_b32 v7, 7, v7
v_lshl_add_u32 v2, v7, 5, v2
s_add_u32 s3, s33, 16384
v_add_u32 v44, s3, v2
v_xor_b32 v45, 32, v44
v_xor_b32 v46, 64, v44
v_xor_b32 v47, 96, v44
v_xor_b32 v48, 128, v44
v_xor_b32 v49, 160, v44
v_xor_b32 v50, 192, v44
v_xor_b32 v51, 224, v44
s_lshl_b32 s3, s24, 6
v_xor_b32 v18, s3, v2
v_xor_b32 v19, 32, v18
v_add_u32 v152, 49152, v18
v_add_u32 v153, 49152, v19
v_lshlrev_b32 v52, 4, v1
s_lshl_b32 s3, s26, 2
s_add_u32 s3, s3, s24
s_lshl_b32 s3, s3, 5
s_add_u32 s3, s3, s34
s_mul_i32 s38, s3, 12288
s_lshl_b32 s3, s28, 2
s_add_u32 s3, s3, s26
s_lshl_b32 s3, s3, 2
s_add_u32 s35, s3, s27
s_mul_i32 s56, s35, 393216
s_add_u32 s56, s56, 201330688
s_mul_i32 s3, s25, 49152
s_add_u32 s39, s56, s3
s_mul_i32 s3, s24, 12288
s_add_u32 s39, s39, s3
s_mul_i32 s3, s35, 256
s_add_u32 s3, s3, 223350784
v_lshrrev_b32 v5, 3, v1
v_add_u32 v5, s27, v5
v_add_u32 v5, 1, v5
v_and_b32 v5, 3, v5
v_lshlrev_b32 v5, 3, v5
v_and_b32 v6, 7, v1
s_lshl_b32 s35, s26, 1
v_add_u32 v7, s35, v6
v_subrev_u32 v7, 1, v7
v_cmp_le_i32 vcc, 7, v7
v_subrev_u32 v2, 7, v7
s_nop 0
v_cndmask_b32 v7, v7, v2, vcc
v_add_u32 v7, 1, v7
v_cmp_eq_u32 vcc, 0, v6
s_nop 1
v_cndmask_b32 v7, v7, v6, vcc
v_add_u32 v6, s25, v7
v_and_b32 v6, 7, v6
v_add_u32 v5, v5, v6
v_lshl_add_u32 v154, v5, 3, s3
s_lshl_b32 s35, s24, 6
s_add_u32 s3, s3, s35
s_lshl_b32 s35, s25, 3
s_add_u32 s3, s3, s35
v_mov_b32 v155, s3
s_add_u32 s54, s25, 2
s_and_b32 s54, s54, 7
s_lshl_b32 s35, s54, 8
s_lshl_b32 s3, s24, 4
s_lshl_b32 s34, s27, 10
s_add_u32 s3, s3, s34
v_add_u32 v5, 0, v3
v_lshlrev_b32 v5, 1, v5
v_xor_b32 v5, v5, v4
v_lshlrev_b32 v5, 4, v5
v_add_u32 v6, s3, v3
v_add_u32 v6, 0, v6
v_lshlrev_b32 v6, 11, v6
v_add3_u32 v5, v5, v6, s35
v_subrev_u32 v148, 0, v5
v_add_u32 v5, 4, v3
v_lshlrev_b32 v5, 1, v5
v_xor_b32 v5, v5, v4
v_lshlrev_b32 v5, 4, v5
v_add_u32 v6, s3, v3
v_add_u32 v6, 4, v6
v_lshlrev_b32 v6, 11, v6
v_add3_u32 v5, v5, v6, s35
v_subrev_u32 v149, 1024, v5
v_add_u32 v5, 0, v3
v_lshlrev_b32 v5, 1, v5
v_xor_b32 v5, v5, v4
v_lshlrev_b32 v5, 4, v5
v_add_u32 v6, s3, v3
v_add_u32 v6, 8, v6
v_lshlrev_b32 v6, 11, v6
v_add3_u32 v5, v5, v6, s35
v_subrev_u32 v150, 2048, v5
v_add_u32 v5, 4, v3
v_lshlrev_b32 v5, 1, v5
v_xor_b32 v5, v5, v4
v_lshlrev_b32 v5, 4, v5
v_add_u32 v6, s3, v3
v_add_u32 v6, 12, v6
v_lshlrev_b32 v6, 11, v6
v_add3_u32 v5, v5, v6, s35
v_subrev_u32 v151, 3072, v5
s_lshl_b32 s3, s28, 2
s_add_u32 s3, s3, s26
s_lshl_b32 s3, s3, 3
s_add_u32 s37, s3, s54
s_lshl_b32 s3, s37, 2
s_add_u32 s3, s3, s27
s_mul_i32 s36, s3, 36864
s_lshl_b32 s35, s24, 10
s_add_u32 s36, s36, s35
s_add_u32 s36, s36, 213913600
s_lshl_b32 s3, s3, 2
s_add_u32 s3, s3, s24
s_mul_i32 s3, s3, 32
s_add_u32 s3, s3, 223358976
v_and_b32 v5, 3, v1
v_lshl_add_u32 v157, v5, 3, s3
s_mul_i32 s3, s26, 192
s_mul_i32 s35, s27, 48
s_add_u32 s3, s3, s35
v_add_u32 v5, s3, v4
v_lshlrev_b32 v5, 12, v5
v_and_b32 v6, 1, v3
v_lshlrev_b32 v6, 5, v6
v_lshrrev_b32 v7, 1, v3
v_lshl_add_u32 v6, v7, 4, v6
s_lshl_b32 s3, s28, 11
s_lshl_b32 s35, s54, 8
s_add_u32 s3, s3, s35
s_lshl_b32 s35, s24, 6
s_add_u32 s3, s3, s35
v_add3_u32 v158, v5, v6, s3
s_sub_u32 s3, s24, s27
s_sub_u32 s3, s3, 1
s_and_b32 s3, s3, 3
s_mul_i32 s3, s3, 12288
s_add_u32 s3, s3, 106496
v_add_u32 v54, s3, v52
v_add_u32 v55, 106496, v52
v_add_u32 v53, 49152, v52
s_add_u32 s55, s0, 1
s_and_b32 s55, s55, 15
s_add_u32 s53, s55, s1
s_and_b32 s53, s53, 3
s_and_b32 s55, s55, 12
s_or_b32 s55, s55, s53
s_lshl_b32 s52, s55, 19
s_lshl_b32 s53, s55, 7
s_add_u32 m0, s32, 16384
s_nop 0
buffer_load_dwordx4 v8, s[8:11], s52 offen offset:0 lds
buffer_load_dwordx4 v9, s[8:11], s52 offen offset:1024 lds
buffer_load_dwordx4 v10, s[8:11], s52 offen offset:2048 lds
buffer_load_dwordx4 v11, s[8:11], s52 offen offset:3072 lds
s_add_u32 m0, s33, 12288
s_nop 0
buffer_load_dwordx4 v12, s[4:7], s53 offen offset:0 lds
buffer_load_dwordx4 v13, s[4:7], s53 offen offset:1024 lds
buffer_load_dwordx4 v14, s[4:7], s53 offen offset:2048 lds
buffer_load_dwordx4 v15, s[4:7], s53 offen offset:3072 lds
s_add_u32 m0, s33, 16384
s_nop 0
buffer_load_dwordx4 v16, s[4:7], s53 offen offset:0 lds
buffer_load_dwordx4 v17, s[4:7], s53 offen offset:1024 lds
s_or_b32 s3, s2, s24
s_cmp_lg_u32 s3, 0
s_cbranch_scc1 L_nononce
s_memrealtime s[58:59]
s_waitcnt lgkmcnt(0)
s_or_b32 s58, s58, 1
v_mov_b32 v60, s58
v_mov_b32 v61, s59
v_mov_b32 v62, 0
buffer_store_dwordx2 v[60:61], v62, s[48:51], 0 offen sc0 sc1
L_nononce:
s_waitcnt vmcnt(10)
s_barrier
ds_read_b128 a[64:67], v28 offset:6144
ds_read_b128 a[68:71], v28 offset:8192
ds_read_b128 a[72:75], v28 offset:10240
ds_read_b64_tr_b16 a[0:1], v20 offset:0
ds_read_b64_tr_b16 a[2:3], v20 offset:1024
ds_read_b64_tr_b16 a[4:5], v21 offset:0
ds_read_b64_tr_b16 a[6:7], v21 offset:1024
ds_read_b64_tr_b16 a[8:9], v22 offset:0
ds_read_b64_tr_b16 a[10:11], v22 offset:1024
ds_read_b64_tr_b16 a[12:13], v23 offset:0
ds_read_b64_tr_b16 a[14:15], v23 offset:1024
ds_read_b64_tr_b16 a[16:17], v24 offset:0
ds_read_b64_tr_b16 a[18:19], v24 offset:1024
ds_read_b64_tr_b16 a[20:21], v25 offset:0
ds_read_b64_tr_b16 a[22:23], v25 offset:1024
ds_read_b64_tr_b16 a[24:25], v26 offset:0
ds_read_b64_tr_b16 a[26:27], v26 offset:1024
ds_read_b64_tr_b16 a[28:29], v27 offset:0
ds_read_b64_tr_b16 a[30:31], v27 offset:1024
s_waitcnt lgkmcnt(0)
v_mfma_f32_16x16x32_bf16 v[160:163], a[0:3], a[64:67], 0
ds_read_b128 a[76:79], v29 offset:6144
s_add_u32 s55, s0, 2
s_and_b32 s55, s55, 15
s_add_u32 s31, s55, s1
s_and_b32 s31, s31, 3
s_and_b32 s55, s55, 12
s_or_b32 s55, s55, s31
s_lshl_b32 s30, s55, 19
s_lshl_b32 s31, s55, 7
s_add_u32 m0, s32, 32768
v_mfma_f32_16x16x32_bf16 v[164:167], a[0:3], a[68:71], 0
ds_read_b128 a[80:83], v29 offset:8192
buffer_load_dwordx4 v8, s[8:11], s30 offen offset:0 lds
v_mfma_f32_16x16x32_bf16 v[168:171], a[0:3], a[72:75], 0
ds_read_b128 a[84:87], v29 offset:10240
v_mfma_f32_16x16x32_bf16 v[172:175], a[4:7], a[64:67], 0
ds_read_b64_tr_b16 a[32:33], v20 offset:8192
buffer_load_dwordx4 v9, s[8:11], s30 offen offset:1024 lds
v_mfma_f32_16x16x32_bf16 v[176:179], a[4:7], a[68:71], 0
ds_read_b64_tr_b16 a[34:35], v20 offset:9216
v_mfma_f32_16x16x32_bf16 v[180:183], a[4:7], a[72:75], 0
ds_read_b64_tr_b16 a[36:37], v21 offset:8192
buffer_load_dwordx4 v10, s[8:11], s30 offen offset:2048 lds
v_mfma_f32_16x16x32_bf16 v[184:187], a[8:11], a[64:67], 0
ds_read_b64_tr_b16 a[38:39], v21 offset:9216
s_add_u32 s55, s0, 3
v_mfma_f32_16x16x32_bf16 v[188:191], a[8:11], a[68:71], 0
ds_read_b64_tr_b16 a[40:41], v22 offset:8192
buffer_load_dwordx4 v11, s[8:11], s30 offen offset:3072 lds
v_mfma_f32_16x16x32_bf16 v[192:195], a[8:11], a[72:75], 0
ds_read_b64_tr_b16 a[42:43], v22 offset:9216
s_add_u32 m0, s33, 0
s_and_b32 s55, s55, 15
v_mfma_f32_16x16x32_bf16 v[196:199], a[12:15], a[64:67], 0
ds_read_b64_tr_b16 a[44:45], v23 offset:8192
buffer_load_dwordx4 v12, s[4:7], s31 offen offset:0 lds
v_mfma_f32_16x16x32_bf16 v[200:203], a[12:15], a[68:71], 0
ds_read_b64_tr_b16 a[46:47], v23 offset:9216
s_add_u32 s53, s55, s1
v_mfma_f32_16x16x32_bf16 v[204:207], a[12:15], a[72:75], 0
ds_read_b64_tr_b16 a[48:49], v24 offset:8192
v_mfma_f32_16x16x32_bf16 v[208:211], a[16:19], a[64:67], 0
ds_read_b64_tr_b16 a[50:51], v24 offset:9216
buffer_load_dwordx4 v13, s[4:7], s31 offen offset:1024 lds
s_and_b32 s53, s53, 3
v_mfma_f32_16x16x32_bf16 v[212:215], a[16:19], a[68:71], 0
ds_read_b64_tr_b16 a[52:53], v25 offset:8192
v_mfma_f32_16x16x32_bf16 v[216:219], a[16:19], a[72:75], 0
ds_read_b64_tr_b16 a[54:55], v25 offset:9216
buffer_load_dwordx4 v14, s[4:7], s31 offen offset:2048 lds
s_and_b32 s55, s55, 12
v_mfma_f32_16x16x32_bf16 v[220:223], a[20:23], a[64:67], 0
ds_read_b64_tr_b16 a[56:57], v26 offset:8192
v_mfma_f32_16x16x32_bf16 v[224:227], a[20:23], a[68:71], 0
ds_read_b64_tr_b16 a[58:59], v26 offset:9216
buffer_load_dwordx4 v15, s[4:7], s31 offen offset:3072 lds
s_or_b32 s55, s55, s53
v_mfma_f32_16x16x32_bf16 v[228:231], a[20:23], a[72:75], 0
ds_read_b64_tr_b16 a[60:61], v27 offset:8192
s_add_u32 m0, s33, 4096
v_mfma_f32_16x16x32_bf16 v[232:235], a[24:27], a[64:67], 0
ds_read_b64_tr_b16 a[62:63], v27 offset:9216
buffer_load_dwordx4 v16, s[4:7], s31 offen offset:0 lds
s_lshl_b32 s52, s55, 19
v_mfma_f32_16x16x32_bf16 v[236:239], a[24:27], a[68:71], 0
v_mfma_f32_16x16x32_bf16 v[240:243], a[24:27], a[72:75], 0
buffer_load_dwordx4 v17, s[4:7], s31 offen offset:1024 lds
s_lshl_b32 s53, s55, 7
v_mfma_f32_16x16x32_bf16 v[244:247], a[28:31], a[64:67], 0
v_mfma_f32_16x16x32_bf16 v[248:251], a[28:31], a[68:71], 0
v_mfma_f32_16x16x32_bf16 v[252:255], a[28:31], a[72:75], 0
s_waitcnt vmcnt(10) lgkmcnt(0)
s_barrier
v_mfma_f32_16x16x32_bf16 v[160:163], a[32:35], a[76:79], v[160:163]
ds_read_b128 a[64:67], v28 offset:12288
s_add_u32 m0, s32, 0
v_mfma_f32_16x16x32_bf16 v[164:167], a[32:35], a[80:83], v[164:167]
ds_read_b128 a[68:71], v28 offset:14336
buffer_load_dwordx4 v8, s[8:11], s52 offen offset:0 lds
v_mfma_f32_16x16x32_bf16 v[168:171], a[32:35], a[84:87], v[168:171]
ds_read_b128 a[72:75], v28 offset:16384
v_mfma_f32_16x16x32_bf16 v[172:175], a[36:39], a[76:79], v[172:175]
ds_read_b64_tr_b16 a[0:1], v20 offset:16384
v_mfma_f32_16x16x32_bf16 v[176:179], a[36:39], a[80:83], v[176:179]
ds_read_b64_tr_b16 a[2:3], v20 offset:17408
v_mfma_f32_16x16x32_bf16 v[180:183], a[36:39], a[84:87], v[180:183]
ds_read_b64_tr_b16 a[4:5], v21 offset:16384
buffer_load_dwordx4 v9, s[8:11], s52 offen offset:1024 lds
v_mfma_f32_16x16x32_bf16 v[184:187], a[40:43], a[76:79], v[184:187]
ds_read_b64_tr_b16 a[6:7], v21 offset:17408
v_mfma_f32_16x16x32_bf16 v[188:191], a[40:43], a[80:83], v[188:191]
ds_read_b64_tr_b16 a[8:9], v22 offset:16384
v_mfma_f32_16x16x32_bf16 v[192:195], a[40:43], a[84:87], v[192:195]
ds_read_b64_tr_b16 a[10:11], v22 offset:17408
v_mfma_f32_16x16x32_bf16 v[196:199], a[44:47], a[76:79], v[196:199]
ds_read_b64_tr_b16 a[12:13], v23 offset:16384
buffer_load_dwordx4 v10, s[8:11], s52 offen offset:2048 lds
v_mfma_f32_16x16x32_bf16 v[200:203], a[44:47], a[80:83], v[200:203]
ds_read_b64_tr_b16 a[14:15], v23 offset:17408
v_mfma_f32_16x16x32_bf16 v[204:207], a[44:47], a[84:87], v[204:207]
ds_read_b64_tr_b16 a[16:17], v24 offset:16384
v_mfma_f32_16x16x32_bf16 v[208:211], a[48:51], a[76:79], v[208:211]
ds_read_b64_tr_b16 a[18:19], v24 offset:17408
v_mfma_f32_16x16x32_bf16 v[212:215], a[48:51], a[80:83], v[212:215]
ds_read_b64_tr_b16 a[20:21], v25 offset:16384
v_mfma_f32_16x16x32_bf16 v[216:219], a[48:51], a[84:87], v[216:219]
ds_read_b64_tr_b16 a[22:23], v25 offset:17408
buffer_load_dwordx4 v11, s[8:11], s52 offen offset:3072 lds
v_mfma_f32_16x16x32_bf16 v[220:223], a[52:55], a[76:79], v[220:223]
ds_read_b64_tr_b16 a[24:25], v26 offset:16384
v_mfma_f32_16x16x32_bf16 v[224:227], a[52:55], a[80:83], v[224:227]
ds_read_b64_tr_b16 a[26:27], v26 offset:17408
v_mfma_f32_16x16x32_bf16 v[228:231], a[52:55], a[84:87], v[228:231]
ds_read_b64_tr_b16 a[28:29], v27 offset:16384
s_add_u32 m0, s33, 6144
v_mfma_f32_16x16x32_bf16 v[232:235], a[56:59], a[76:79], v[232:235]
ds_read_b64_tr_b16 a[30:31], v27 offset:17408
buffer_load_dwordx4 v12, s[4:7], s53 offen offset:0 lds
v_mfma_f32_16x16x32_bf16 v[236:239], a[56:59], a[80:83], v[236:239]
v_mfma_f32_16x16x32_bf16 v[240:243], a[56:59], a[84:87], v[240:243]
v_mfma_f32_16x16x32_bf16 v[244:247], a[60:63], a[76:79], v[244:247]
v_mfma_f32_16x16x32_bf16 v[248:251], a[60:63], a[80:83], v[248:251]
v_mfma_f32_16x16x32_bf16 v[252:255], a[60:63], a[84:87], v[252:255]
s_waitcnt lgkmcnt(0)
v_mfma_f32_16x16x32_bf16 v[160:163], a[0:3], a[64:67], v[160:163]
ds_read_b128 a[76:79], v29 offset:12288
v_mfma_f32_16x16x32_bf16 v[164:167], a[0:3], a[68:71], v[164:167]
ds_read_b128 a[80:83], v29 offset:14336
buffer_load_dwordx4 v13, s[4:7], s53 offen offset:1024 lds
v_mfma_f32_16x16x32_bf16 v[168:171], a[0:3], a[72:75], v[168:171]
ds_read_b128 a[84:87], v29 offset:16384
s_add_u32 s55, s0, 4
v_mfma_f32_16x16x32_bf16 v[172:175], a[4:7], a[64:67], v[172:175]
ds_read_b64_tr_b16 a[32:33], v20 offset:24576
v_mfma_f32_16x16x32_bf16 v[176:179], a[4:7], a[68:71], v[176:179]
ds_read_b64_tr_b16 a[34:35], v20 offset:25600
s_and_b32 s55, s55, 15
v_mfma_f32_16x16x32_bf16 v[180:183], a[4:7], a[72:75], v[180:183]
ds_read_b64_tr_b16 a[36:37], v21 offset:24576
buffer_load_dwordx4 v14, s[4:7], s53 offen offset:2048 lds
v_mfma_f32_16x16x32_bf16 v[184:187], a[8:11], a[64:67], v[184:187]
ds_read_b64_tr_b16 a[38:39], v21 offset:25600
s_add_u32 s31, s55, s1
v_mfma_f32_16x16x32_bf16 v[188:191], a[8:11], a[68:71], v[188:191]
ds_read_b64_tr_b16 a[40:41], v22 offset:24576
v_mfma_f32_16x16x32_bf16 v[192:195], a[8:11], a[72:75], v[192:195]
ds_read_b64_tr_b16 a[42:43], v22 offset:25600
s_and_b32 s31, s31, 3
v_mfma_f32_16x16x32_bf16 v[196:199], a[12:15], a[64:67], v[196:199]
ds_read_b64_tr_b16 a[44:45], v23 offset:24576
buffer_load_dwordx4 v15, s[4:7], s53 offen offset:3072 lds
v_mfma_f32_16x16x32_bf16 v[200:203], a[12:15], a[68:71], v[200:203]
ds_read_b64_tr_b16 a[46:47], v23 offset:25600
s_and_b32 s55, s55, 12
v_mfma_f32_16x16x32_bf16 v[204:207], a[12:15], a[72:75], v[204:207]
ds_read_b64_tr_b16 a[48:49], v24 offset:24576
v_mfma_f32_16x16x32_bf16 v[208:211], a[16:19], a[64:67], v[208:211]
ds_read_b64_tr_b16 a[50:51], v24 offset:25600
s_or_b32 s55, s55, s31
v_mfma_f32_16x16x32_bf16 v[212:215], a[16:19], a[68:71], v[212:215]
ds_read_b64_tr_b16 a[52:53], v25 offset:24576
s_add_u32 m0, s33, 10240
v_mfma_f32_16x16x32_bf16 v[216:219], a[16:19], a[72:75], v[216:219]
ds_read_b64_tr_b16 a[54:55], v25 offset:25600
buffer_load_dwordx4 v16, s[4:7], s53 offen offset:0 lds
s_lshl_b32 s30, s55, 19
v_mfma_f32_16x16x32_bf16 v[220:223], a[20:23], a[64:67], v[220:223]
ds_read_b64_tr_b16 a[56:57], v26 offset:24576
v_mfma_f32_16x16x32_bf16 v[224:227], a[20:23], a[68:71], v[224:227]
ds_read_b64_tr_b16 a[58:59], v26 offset:25600
s_lshl_b32 s31, s55, 7
v_mfma_f32_16x16x32_bf16 v[228:231], a[20:23], a[72:75], v[228:231]
ds_read_b64_tr_b16 a[60:61], v27 offset:24576
v_mfma_f32_16x16x32_bf16 v[232:235], a[24:27], a[64:67], v[232:235]
ds_read_b64_tr_b16 a[62:63], v27 offset:25600
buffer_load_dwordx4 v17, s[4:7], s53 offen offset:1024 lds
v_mfma_f32_16x16x32_bf16 v[236:239], a[24:27], a[68:71], v[236:239]
v_mfma_f32_16x16x32_bf16 v[240:243], a[24:27], a[72:75], v[240:243]
v_mfma_f32_16x16x32_bf16 v[244:247], a[28:31], a[64:67], v[244:247]
v_mfma_f32_16x16x32_bf16 v[248:251], a[28:31], a[68:71], v[248:251]
v_mfma_f32_16x16x32_bf16 v[252:255], a[28:31], a[72:75], v[252:255]
s_waitcnt vmcnt(10) lgkmcnt(0)
s_barrier
v_mfma_f32_16x16x32_bf16 v[160:163], a[32:35], a[76:79], v[160:163]
ds_read_b128 a[64:67], v28 offset:0
s_add_u32 m0, s32, 16384
v_mfma_f32_16x16x32_bf16 v[164:167], a[32:35], a[80:83], v[164:167]
ds_read_b128 a[68:71], v28 offset:2048
buffer_load_dwordx4 v8, s[8:11], s30 offen offset:0 lds
v_mfma_f32_16x16x32_bf16 v[168:171], a[32:35], a[84:87], v[168:171]
ds_read_b128 a[72:75], v28 offset:4096
v_mfma_f32_16x16x32_bf16 v[172:175], a[36:39], a[76:79], v[172:175]
ds_read_b64_tr_b16 a[0:1], v20 offset:32768
v_mfma_f32_16x16x32_bf16 v[176:179], a[36:39], a[80:83], v[176:179]
ds_read_b64_tr_b16 a[2:3], v20 offset:33792
v_mfma_f32_16x16x32_bf16 v[180:183], a[36:39], a[84:87], v[180:183]
ds_read_b64_tr_b16 a[4:5], v21 offset:32768
buffer_load_dwordx4 v9, s[8:11], s30 offen offset:1024 lds
v_mfma_f32_16x16x32_bf16 v[184:187], a[40:43], a[76:79], v[184:187]
ds_read_b64_tr_b16 a[6:7], v21 offset:33792
v_mfma_f32_16x16x32_bf16 v[188:191], a[40:43], a[80:83], v[188:191]
ds_read_b64_tr_b16 a[8:9], v22 offset:32768
v_mfma_f32_16x16x32_bf16 v[192:195], a[40:43], a[84:87], v[192:195]
ds_read_b64_tr_b16 a[10:11], v22 offset:33792
v_mfma_f32_16x16x32_bf16 v[196:199], a[44:47], a[76:79], v[196:199]
ds_read_b64_tr_b16 a[12:13], v23 offset:32768
buffer_load_dwordx4 v10, s[8:11], s30 offen offset:2048 lds
v_mfma_f32_16x16x32_bf16 v[200:203], a[44:47], a[80:83], v[200:203]
ds_read_b64_tr_b16 a[14:15], v23 offset:33792
v_mfma_f32_16x16x32_bf16 v[204:207], a[44:47], a[84:87], v[204:207]
ds_read_b64_tr_b16 a[16:17], v24 offset:32768
v_mfma_f32_16x16x32_bf16 v[208:211], a[48:51], a[76:79], v[208:211]
ds_read_b64_tr_b16 a[18:19], v24 offset:33792
v_mfma_f32_16x16x32_bf16 v[212:215], a[48:51], a[80:83], v[212:215]
ds_read_b64_tr_b16 a[20:21], v25 offset:32768
v_mfma_f32_16x16x32_bf16 v[216:219], a[48:51], a[84:87], v[216:219]
ds_read_b64_tr_b16 a[22:23], v25 offset:33792
buffer_load_dwordx4 v11, s[8:11], s30 offen offset:3072 lds
v_mfma_f32_16x16x32_bf16 v[220:223], a[52:55], a[76:79], v[220:223]
ds_read_b64_tr_b16 a[24:25], v26 offset:32768
v_mfma_f32_16x16x32_bf16 v[224:227], a[52:55], a[80:83], v[224:227]
ds_read_b64_tr_b16 a[26:27], v26 offset:33792
v_mfma_f32_16x16x32_bf16 v[228:231], a[52:55], a[84:87], v[228:231]
ds_read_b64_tr_b16 a[28:29], v27 offset:32768
s_add_u32 m0, s33, 12288
v_mfma_f32_16x16x32_bf16 v[232:235], a[56:59], a[76:79], v[232:235]
ds_read_b64_tr_b16 a[30:31], v27 offset:33792
buffer_load_dwordx4 v12, s[4:7], s31 offen offset:0 lds
v_mfma_f32_16x16x32_bf16 v[236:239], a[56:59], a[80:83], v[236:239]
v_mfma_f32_16x16x32_bf16 v[240:243], a[56:59], a[84:87], v[240:243]
v_mfma_f32_16x16x32_bf16 v[244:247], a[60:63], a[76:79], v[244:247]
v_mfma_f32_16x16x32_bf16 v[248:251], a[60:63], a[80:83], v[248:251]
v_mfma_f32_16x16x32_bf16 v[252:255], a[60:63], a[84:87], v[252:255]
s_waitcnt lgkmcnt(0)
v_mfma_f32_16x16x32_bf16 v[160:163], a[0:3], a[64:67], v[160:163]
ds_read_b128 a[76:79], v29 offset:0
v_mfma_f32_16x16x32_bf16 v[164:167], a[0:3], a[68:71], v[164:167]
ds_read_b128 a[80:83], v29 offset:2048
buffer_load_dwordx4 v13, s[4:7], s31 offen offset:1024 lds
v_mfma_f32_16x16x32_bf16 v[168:171], a[0:3], a[72:75], v[168:171]
ds_read_b128 a[84:87], v29 offset:4096
s_add_u32 s55, s0, 5
v_mfma_f32_16x16x32_bf16 v[172:175], a[4:7], a[64:67], v[172:175]
ds_read_b64_tr_b16 a[32:33], v20 offset:40960
v_mfma_f32_16x16x32_bf16 v[176:179], a[4:7], a[68:71], v[176:179]
ds_read_b64_tr_b16 a[34:35], v20 offset:41984
s_and_b32 s55, s55, 15
v_mfma_f32_16x16x32_bf16 v[180:183], a[4:7], a[72:75], v[180:183]
ds_read_b64_tr_b16 a[36:37], v21 offset:40960
buffer_load_dwordx4 v14, s[4:7], s31 offen offset:2048 lds
v_mfma_f32_16x16x32_bf16 v[184:187], a[8:11], a[64:67], v[184:187]
ds_read_b64_tr_b16 a[38:39], v21 offset:41984
s_add_u32 s53, s55, s1
v_mfma_f32_16x16x32_bf16 v[188:191], a[8:11], a[68:71], v[188:191]
ds_read_b64_tr_b16 a[40:41], v22 offset:40960
v_mfma_f32_16x16x32_bf16 v[192:195], a[8:11], a[72:75], v[192:195]
ds_read_b64_tr_b16 a[42:43], v22 offset:41984
s_and_b32 s53, s53, 3
v_mfma_f32_16x16x32_bf16 v[196:199], a[12:15], a[64:67], v[196:199]
ds_read_b64_tr_b16 a[44:45], v23 offset:40960
buffer_load_dwordx4 v15, s[4:7], s31 offen offset:3072 lds
v_mfma_f32_16x16x32_bf16 v[200:203], a[12:15], a[68:71], v[200:203]
ds_read_b64_tr_b16 a[46:47], v23 offset:41984
s_and_b32 s55, s55, 12
v_mfma_f32_16x16x32_bf16 v[204:207], a[12:15], a[72:75], v[204:207]
ds_read_b64_tr_b16 a[48:49], v24 offset:40960
v_mfma_f32_16x16x32_bf16 v[208:211], a[16:19], a[64:67], v[208:211]
ds_read_b64_tr_b16 a[50:51], v24 offset:41984
s_or_b32 s55, s55, s53
v_mfma_f32_16x16x32_bf16 v[212:215], a[16:19], a[68:71], v[212:215]
ds_read_b64_tr_b16 a[52:53], v25 offset:40960
s_add_u32 m0, s33, 16384
v_mfma_f32_16x16x32_bf16 v[216:219], a[16:19], a[72:75], v[216:219]
ds_read_b64_tr_b16 a[54:55], v25 offset:41984
buffer_load_dwordx4 v16, s[4:7], s31 offen offset:0 lds
s_lshl_b32 s52, s55, 19
v_mfma_f32_16x16x32_bf16 v[220:223], a[20:23], a[64:67], v[220:223]
ds_read_b64_tr_b16 a[56:57], v26 offset:40960
v_mfma_f32_16x16x32_bf16 v[224:227], a[20:23], a[68:71], v[224:227]
ds_read_b64_tr_b16 a[58:59], v26 offset:41984
s_lshl_b32 s53, s55, 7
v_mfma_f32_16x16x32_bf16 v[228:231], a[20:23], a[72:75], v[228:231]
ds_read_b64_tr_b16 a[60:61], v27 offset:40960
v_mfma_f32_16x16x32_bf16 v[232:235], a[24:27], a[64:67], v[232:235]
ds_read_b64_tr_b16 a[62:63], v27 offset:41984
buffer_load_dwordx4 v17, s[4:7], s31 offen offset:1024 lds
v_mfma_f32_16x16x32_bf16 v[236:239], a[24:27], a[68:71], v[236:239]
v_mfma_f32_16x16x32_bf16 v[240:243], a[24:27], a[72:75], v[240:243]
v_mfma_f32_16x16x32_bf16 v[244:247], a[28:31], a[64:67], v[244:247]
v_mfma_f32_16x16x32_bf16 v[248:251], a[28:31], a[68:71], v[248:251]
v_mfma_f32_16x16x32_bf16 v[252:255], a[28:31], a[72:75], v[252:255]
s_waitcnt vmcnt(10) lgkmcnt(0)
s_barrier
v_mfma_f32_16x16x32_bf16 v[160:163], a[32:35], a[76:79], v[160:163]
ds_read_b128 a[64:67], v28 offset:6144
s_add_u32 m0, s32, 32768
v_mfma_f32_16x16x32_bf16 v[164:167], a[32:35], a[80:83], v[164:167]
ds_read_b128 a[68:71], v28 offset:8192
buffer_load_dwordx4 v8, s[8:11], s52 offen offset:0 lds
v_mfma_f32_16x16x32_bf16 v[168:171], a[32:35], a[84:87], v[168:171]
ds_read_b128 a[72:75], v28 offset:10240
v_mfma_f32_16x16x32_bf16 v[172:175], a[36:39], a[76:79], v[172:175]
ds_read_b64_tr_b16 a[0:1], v20 offset:0
v_mfma_f32_16x16x32_bf16 v[176:179], a[36:39], a[80:83], v[176:179]
ds_read_b64_tr_b16 a[2:3], v20 offset:1024
buffer_load_dwordx4 v9, s[8:11], s52 offen offset:1024 lds
v_mfma_f32_16x16x32_bf16 v[180:183], a[36:39], a[84:87], v[180:183]
ds_read_b64_tr_b16 a[4:5], v21 offset:0
v_mfma_f32_16x16x32_bf16 v[184:187], a[40:43], a[76:79], v[184:187]
ds_read_b64_tr_b16 a[6:7], v21 offset:1024
v_mfma_f32_16x16x32_bf16 v[188:191], a[40:43], a[80:83], v[188:191]
ds_read_b64_tr_b16 a[8:9], v22 offset:0
buffer_load_dwordx4 v10, s[8:11], s52 offen offset:2048 lds
v_mfma_f32_16x16x32_bf16 v[192:195], a[40:43], a[84:87], v[192:195]
ds_read_b64_tr_b16 a[10:11], v22 offset:1024
v_mfma_f32_16x16x32_bf16 v[196:199], a[44:47], a[76:79], v[196:199]
ds_read_b64_tr_b16 a[12:13], v23 offset:0
v_mfma_f32_16x16x32_bf16 v[200:203], a[44:47], a[80:83], v[200:203]
ds_read_b64_tr_b16 a[14:15], v23 offset:1024
buffer_load_dwordx4 v11, s[8:11], s52 offen offset:3072 lds
v_mfma_f32_16x16x32_bf16 v[204:207], a[44:47], a[84:87], v[204:207]
ds_read_b64_tr_b16 a[16:17], v24 offset:0
v_mfma_f32_16x16x32_bf16 v[208:211], a[48:51], a[76:79], v[208:211]
ds_read_b64_tr_b16 a[18:19], v24 offset:1024
s_add_u32 m0, s33, 18432
s_add_u32 s35, s38, 0
v_mfma_f32_16x16x32_bf16 v[212:215], a[48:51], a[80:83], v[212:215]
ds_read_b64_tr_b16 a[20:21], v25 offset:0
buffer_load_dwordx4 v30, s[12:15], s35 offen offset:0 nt lds
v_mfma_f32_16x16x32_bf16 v[216:219], a[48:51], a[84:87], v[216:219]
ds_read_b64_tr_b16 a[22:23], v25 offset:1024
v_mfma_f32_16x16x32_bf16 v[220:223], a[52:55], a[76:79], v[220:223]
ds_read_b64_tr_b16 a[24:25], v26 offset:0
s_add_u32 s35, s38, 0
v_mfma_f32_16x16x32_bf16 v[224:227], a[52:55], a[80:83], v[224:227]
ds_read_b64_tr_b16 a[26:27], v26 offset:1024
buffer_load_dwordx4 v31, s[12:15], s35 offen offset:1024 nt lds
v_mfma_f32_16x16x32_bf16 v[228:231], a[52:55], a[84:87], v[228:231]
ds_read_b64_tr_b16 a[28:29], v27 offset:0
v_mfma_f32_16x16x32_bf16 v[232:235], a[56:59], a[76:79], v[232:235]
ds_read_b64_tr_b16 a[30:31], v27 offset:1024
s_add_u32 m0, s33, 0
v_mfma_f32_16x16x32_bf16 v[236:239], a[56:59], a[80:83], v[236:239]
buffer_load_dwordx4 v12, s[4:7], s53 offen offset:0 lds
v_mfma_f32_16x16x32_bf16 v[240:243], a[56:59], a[84:87], v[240:243]
v_mfma_f32_16x16x32_bf16 v[244:247], a[60:63], a[76:79], v[244:247]
v_mfma_f32_16x16x32_bf16 v[248:251], a[60:63], a[80:83], v[248:251]
v_mfma_f32_16x16x32_bf16 v[252:255], a[60:63], a[84:87], v[252:255]
s_waitcnt lgkmcnt(0)
v_mfma_f32_16x16x32_bf16 v[160:163], a[0:3], a[64:67], v[160:163]
ds_read_b128 a[76:79], v29 offset:6144
v_mfma_f32_16x16x32_bf16 v[164:167], a[0:3], a[68:71], v[164:167]
ds_read_b128 a[80:83], v29 offset:8192
buffer_load_dwordx4 v13, s[4:7], s53 offen offset:1024 lds
v_mfma_f32_16x16x32_bf16 v[168:171], a[0:3], a[72:75], v[168:171]
ds_read_b128 a[84:87], v29 offset:10240
s_add_u32 s55, s0, 6
v_mfma_f32_16x16x32_bf16 v[172:175], a[4:7], a[64:67], v[172:175]
ds_read_b64_tr_b16 a[32:33], v20 offset:8192
s_mov_b32 s57, s25
v_mfma_f32_16x16x32_bf16 v[176:179], a[4:7], a[68:71], v[176:179]
ds_read_b64_tr_b16 a[34:35], v20 offset:9216
buffer_load_dwordx4 v14, s[4:7], s53 offen offset:2048 lds
s_and_b32 s55, s55, 15
v_mfma_f32_16x16x32_bf16 v[180:183], a[4:7], a[72:75], v[180:183]
ds_read_b64_tr_b16 a[36:37], v21 offset:8192
s_lshl_b32 s78, s57, 18
v_mfma_f32_16x16x32_bf16 v[184:187], a[8:11], a[64:67], v[184:187]
ds_read_b64_tr_b16 a[38:39], v21 offset:9216
s_add_u32 s31, s55, s1
v_mfma_f32_16x16x32_bf16 v[188:191], a[8:11], a[68:71], v[188:191]
ds_read_b64_tr_b16 a[40:41], v22 offset:8192
buffer_load_dwordx4 v15, s[4:7], s53 offen offset:3072 lds
v_mfma_f32_16x16x32_bf16 v[192:195], a[8:11], a[72:75], v[192:195]
ds_read_b64_tr_b16 a[42:43], v22 offset:9216
s_and_b32 s31, s31, 3
v_mfma_f32_16x16x32_bf16 v[196:199], a[12:15], a[64:67], v[196:199]
ds_read_b64_tr_b16 a[44:45], v23 offset:8192
s_add_u32 m0, s33, 18432
s_add_u32 s35, s38, 0
v_mfma_f32_16x16x32_bf16 v[200:203], a[12:15], a[68:71], v[200:203]
ds_read_b64_tr_b16 a[46:47], v23 offset:9216
buffer_load_dwordx4 v32, s[12:15], s35 offen offset:2048 nt lds
s_and_b32 s55, s55, 12
v_mfma_f32_16x16x32_bf16 v[204:207], a[12:15], a[72:75], v[204:207]
ds_read_b64_tr_b16 a[48:49], v24 offset:8192
s_lshl_b32 s57, s26, 1
v_mfma_f32_16x16x32_bf16 v[208:211], a[16:19], a[64:67], v[208:211]
ds_read_b64_tr_b16 a[50:51], v24 offset:9216
s_add_u32 s35, s38, 0
s_or_b32 s55, s55, s31
v_mfma_f32_16x16x32_bf16 v[212:215], a[16:19], a[68:71], v[212:215]
ds_read_b64_tr_b16 a[52:53], v25 offset:8192
buffer_load_dwordx4 v33, s[12:15], s35 offen offset:3072 nt lds
v_mfma_f32_16x16x32_bf16 v[216:219], a[16:19], a[72:75], v[216:219]
ds_read_b64_tr_b16 a[54:55], v25 offset:9216
s_lshl_b32 s30, s55, 19
v_mfma_f32_16x16x32_bf16 v[220:223], a[20:23], a[64:67], v[220:223]
ds_read_b64_tr_b16 a[56:57], v26 offset:8192
s_add_u32 m0, s33, 4096
v_mfma_f32_16x16x32_bf16 v[224:227], a[20:23], a[68:71], v[224:227]
ds_read_b64_tr_b16 a[58:59], v26 offset:9216
buffer_load_dwordx4 v16, s[4:7], s53 offen offset:0 lds
s_lshl_b32 s31, s55, 7
v_mfma_f32_16x16x32_bf16 v[228:231], a[20:23], a[72:75], v[228:231]
ds_read_b64_tr_b16 a[60:61], v27 offset:8192
s_add_u32 s57, s57, 0
v_mfma_f32_16x16x32_bf16 v[232:235], a[24:27], a[64:67], v[232:235]
ds_read_b64_tr_b16 a[62:63], v27 offset:9216
v_mfma_f32_16x16x32_bf16 v[236:239], a[24:27], a[68:71], v[236:239]
buffer_load_dwordx4 v17, s[4:7], s53 offen offset:1024 lds
s_cmp_ge_u32 s57, 7
s_cselect_b32 s58, 7, 0
v_mfma_f32_16x16x32_bf16 v[240:243], a[24:27], a[72:75], v[240:243]
v_mfma_f32_16x16x32_bf16 v[244:247], a[28:31], a[64:67], v[244:247]
s_sub_u32 s57, s57, s58
v_mfma_f32_16x16x32_bf16 v[248:251], a[28:31], a[68:71], v[248:251]
v_mfma_f32_16x16x32_bf16 v[252:255], a[28:31], a[72:75], v[252:255]
s_add_u32 s57, s57, s25
s_waitcnt vmcnt(14) lgkmcnt(0)
s_barrier
v_mfma_f32_16x16x32_bf16 v[160:163], a[32:35], a[76:79], v[160:163]
ds_read_b128 a[64:67], v28 offset:12288
s_add_u32 m0, s32, 0
v_mfma_f32_16x16x32_bf16 v[164:167], a[32:35], a[80:83], v[164:167]
ds_read_b128 a[68:71], v28 offset:14336
buffer_load_dwordx4 v8, s[8:11], s30 offen offset:0 lds
v_mfma_f32_16x16x32_bf16 v[168:171], a[32:35], a[84:87], v[168:171]
ds_read_b128 a[72:75], v28 offset:16384
v_mfma_f32_16x16x32_bf16 v[172:175], a[36:39], a[76:79], v[172:175]
ds_read_b64_tr_b16 a[0:1], v20 offset:16384
s_add_u32 s57, s57, 1
v_mfma_f32_16x16x32_bf16 v[176:179], a[36:39], a[80:83], v[176:179]
ds_read_b64_tr_b16 a[2:3], v20 offset:17408
v_mfma_f32_16x16x32_bf16 v[180:183], a[36:39], a[84:87], v[180:183]
ds_read_b64_tr_b16 a[4:5], v21 offset:16384
buffer_load_dwordx4 v9, s[8:11], s30 offen offset:1024 lds
v_mfma_f32_16x16x32_bf16 v[184:187], a[40:43], a[76:79], v[184:187]
ds_read_b64_tr_b16 a[6:7], v21 offset:17408
v_mfma_f32_16x16x32_bf16 v[188:191], a[40:43], a[80:83], v[188:191]
ds_read_b64_tr_b16 a[8:9], v22 offset:16384
s_and_b32 s57, s57, 7
v_mfma_f32_16x16x32_bf16 v[192:195], a[40:43], a[84:87], v[192:195]
ds_read_b64_tr_b16 a[10:11], v22 offset:17408
v_mfma_f32_16x16x32_bf16 v[196:199], a[44:47], a[76:79], v[196:199]
ds_read_b64_tr_b16 a[12:13], v23 offset:16384
buffer_load_dwordx4 v10, s[8:11], s30 offen offset:2048 lds
v_mfma_f32_16x16x32_bf16 v[200:203], a[44:47], a[80:83], v[200:203]
ds_read_b64_tr_b16 a[14:15], v23 offset:17408
v_mfma_f32_16x16x32_bf16 v[204:207], a[44:47], a[84:87], v[204:207]
ds_read_b64_tr_b16 a[16:17], v24 offset:16384
s_lshl_b32 s79, s57, 18
v_mfma_f32_16x16x32_bf16 v[208:211], a[48:51], a[76:79], v[208:211]
ds_read_b64_tr_b16 a[18:19], v24 offset:17408
v_mfma_f32_16x16x32_bf16 v[212:215], a[48:51], a[80:83], v[212:215]
ds_read_b64_tr_b16 a[20:21], v25 offset:16384
s_mul_i32 s57, s57, 49152
v_mfma_f32_16x16x32_bf16 v[216:219], a[48:51], a[84:87], v[216:219]
ds_read_b64_tr_b16 a[22:23], v25 offset:17408
buffer_load_dwordx4 v11, s[8:11], s30 offen offset:3072 lds
v_mfma_f32_16x16x32_bf16 v[220:223], a[52:55], a[76:79], v[220:223]
ds_read_b64_tr_b16 a[24:25], v26 offset:16384
s_add_u32 s57, s57, s56
v_mfma_f32_16x16x32_bf16 v[224:227], a[52:55], a[80:83], v[224:227]
ds_read_b64_tr_b16 a[26:27], v26 offset:17408
v_mfma_f32_16x16x32_bf16 v[228:231], a[52:55], a[84:87], v[228:231]
ds_read_b64_tr_b16 a[28:29], v27 offset:16384
s_add_u32 m0, s33, 6144
v_mfma_f32_16x16x32_bf16 v[232:235], a[56:59], a[76:79], v[232:235]
ds_read_b64_tr_b16 a[30:31], v27 offset:17408
buffer_load_dwordx4 v12, s[4:7], s31 offen offset:0 lds
v_mfma_f32_16x16x32_bf16 v[236:239], a[56:59], a[80:83], v[236:239]
s_mul_i32 s59, s24, 3072
v_mfma_f32_16x16x32_bf16 v[240:243], a[56:59], a[84:87], v[240:243]
v_mfma_f32_16x16x32_bf16 v[244:247], a[60:63], a[76:79], v[244:247]
s_add_u32 s64, s57, s59
v_mfma_f32_16x16x32_bf16 v[248:251], a[60:63], a[80:83], v[248:251]
v_mfma_f32_16x16x32_bf16 v[252:255], a[60:63], a[84:87], v[252:255]
s_lshl_b32 s57, s26, 1
s_waitcnt lgkmcnt(0)
v_mfma_f32_16x16x32_bf16 v[160:163], a[0:3], a[64:67], v[160:163]
ds_read_b128 a[76:79], v29 offset:12288
v_mfma_f32_16x16x32_bf16 v[164:167], a[0:3], a[68:71], v[164:167]
ds_read_b128 a[80:83], v29 offset:14336
buffer_load_dwordx4 v13, s[4:7], s31 offen offset:1024 lds
v_mfma_f32_16x16x32_bf16 v[168:171], a[0:3], a[72:75], v[168:171]
ds_read_b128 a[84:87], v29 offset:16384
s_add_u32 s55, s0, 7
v_mfma_f32_16x16x32_bf16 v[172:175], a[4:7], a[64:67], v[172:175]
ds_read_b64_tr_b16 a[32:33], v20 offset:24576
s_add_u32 s57, s57, 1
v_mfma_f32_16x16x32_bf16 v[176:179], a[4:7], a[68:71], v[176:179]
ds_read_b64_tr_b16 a[34:35], v20 offset:25600
s_and_b32 s55, s55, 15
v_mfma_f32_16x16x32_bf16 v[180:183], a[4:7], a[72:75], v[180:183]
ds_read_b64_tr_b16 a[36:37], v21 offset:24576
buffer_load_dwordx4 v14, s[4:7], s31 offen offset:2048 lds
v_mfma_f32_16x16x32_bf16 v[184:187], a[8:11], a[64:67], v[184:187]
ds_read_b64_tr_b16 a[38:39], v21 offset:25600
s_add_u32 s53, s55, s1
v_mfma_f32_16x16x32_bf16 v[188:191], a[8:11], a[68:71], v[188:191]
ds_read_b64_tr_b16 a[40:41], v22 offset:24576
s_cmp_ge_u32 s57, 7
s_cselect_b32 s58, 7, 0
v_mfma_f32_16x16x32_bf16 v[192:195], a[8:11], a[72:75], v[192:195]
ds_read_b64_tr_b16 a[42:43], v22 offset:25600
s_and_b32 s53, s53, 3
v_mfma_f32_16x16x32_bf16 v[196:199], a[12:15], a[64:67], v[196:199]
ds_read_b64_tr_b16 a[44:45], v23 offset:24576
buffer_load_dwordx4 v15, s[4:7], s31 offen offset:3072 lds
v_mfma_f32_16x16x32_bf16 v[200:203], a[12:15], a[68:71], v[200:203]
ds_read_b64_tr_b16 a[46:47], v23 offset:25600
s_and_b32 s55, s55, 12
v_mfma_f32_16x16x32_bf16 v[204:207], a[12:15], a[72:75], v[204:207]
ds_read_b64_tr_b16 a[48:49], v24 offset:24576
s_sub_u32 s57, s57, s58
v_mfma_f32_16x16x32_bf16 v[208:211], a[16:19], a[64:67], v[208:211]
ds_read_b64_tr_b16 a[50:51], v24 offset:25600
s_or_b32 s55, s55, s53
v_mfma_f32_16x16x32_bf16 v[212:215], a[16:19], a[68:71], v[212:215]
ds_read_b64_tr_b16 a[52:53], v25 offset:24576
s_add_u32 m0, s33, 10240
v_mfma_f32_16x16x32_bf16 v[216:219], a[16:19], a[72:75], v[216:219]
ds_read_b64_tr_b16 a[54:55], v25 offset:25600
buffer_load_dwordx4 v16, s[4:7], s31 offen offset:0 lds
s_lshl_b32 s52, s55, 19
v_mfma_f32_16x16x32_bf16 v[220:223], a[20:23], a[64:67], v[220:223]
ds_read_b64_tr_b16 a[56:57], v26 offset:24576
s_add_u32 s57, s57, s25
v_mfma_f32_16x16x32_bf16 v[224:227], a[20:23], a[68:71], v[224:227]
ds_read_b64_tr_b16 a[58:59], v26 offset:25600
s_lshl_b32 s53, s55, 7
v_mfma_f32_16x16x32_bf16 v[228:231], a[20:23], a[72:75], v[228:231]
ds_read_b64_tr_b16 a[60:61], v27 offset:24576
s_add_u32 s57, s57, 1
v_mfma_f32_16x16x32_bf16 v[232:235], a[24:27], a[64:67], v[232:235]
ds_read_b64_tr_b16 a[62:63], v27 offset:25600
buffer_load_dwordx4 v17, s[4:7], s31 offen offset:1024 lds
v_mfma_f32_16x16x32_bf16 v[236:239], a[24:27], a[68:71], v[236:239]
s_and_b32 s57, s57, 7
v_mfma_f32_16x16x32_bf16 v[240:243], a[24:27], a[72:75], v[240:243]
v_mfma_f32_16x16x32_bf16 v[244:247], a[28:31], a[64:67], v[244:247]
s_lshl_b32 s80, s57, 18
v_mfma_f32_16x16x32_bf16 v[248:251], a[28:31], a[68:71], v[248:251]
v_mfma_f32_16x16x32_bf16 v[252:255], a[28:31], a[72:75], v[252:255]
s_mul_i32 s57, s57, 49152
s_waitcnt vmcnt(10) lgkmcnt(0)
s_barrier
v_mfma_f32_16x16x32_bf16 v[160:163], a[32:35], a[76:79], v[160:163]
ds_read_b128 a[64:67], v28 offset:0
ds_read_b128 a[68:71], v28 offset:2048
s_add_u32 m0, s32, 16384
v_mfma_f32_16x16x32_bf16 v[164:167], a[32:35], a[80:83], v[164:167]
ds_read_b128 a[72:75], v28 offset:4096
ds_read_b64_tr_b16 a[0:1], v20 offset:32768
buffer_load_dwordx4 v8, s[8:11], s52 offen offset:0 lds
v_mfma_f32_16x16x32_bf16 v[168:171], a[32:35], a[84:87], v[168:171]
ds_read_b64_tr_b16 a[2:3], v20 offset:33792
ds_read_b64_tr_b16 a[4:5], v21 offset:32768
v_mfma_f32_16x16x32_bf16 v[172:175], a[36:39], a[76:79], v[172:175]
ds_read_b64_tr_b16 a[6:7], v21 offset:33792
s_add_u32 s57, s57, s56
v_mfma_f32_16x16x32_bf16 v[176:179], a[36:39], a[80:83], v[176:179]
ds_read_b64_tr_b16 a[8:9], v22 offset:32768
v_mfma_f32_16x16x32_bf16 v[180:183], a[36:39], a[84:87], v[180:183]
ds_read_b64_tr_b16 a[10:11], v22 offset:33792
buffer_load_dwordx4 v9, s[8:11], s52 offen offset:1024 lds
v_mfma_f32_16x16x32_bf16 v[184:187], a[40:43], a[76:79], v[184:187]
ds_read_b64_tr_b16 a[12:13], v23 offset:32768
v_mfma_f32_16x16x32_bf16 v[188:191], a[40:43], a[80:83], v[188:191]
ds_read_b64_tr_b16 a[14:15], v23 offset:33792
s_mul_i32 s59, s24, 3072
v_mfma_f32_16x16x32_bf16 v[192:195], a[40:43], a[84:87], v[192:195]
ds_read_b64_tr_b16 a[16:17], v24 offset:32768
v_mfma_f32_16x16x32_bf16 v[196:199], a[44:47], a[76:79], v[196:199]
ds_read_b64_tr_b16 a[18:19], v24 offset:33792
buffer_load_dwordx4 v10, s[8:11], s52 offen offset:2048 lds
v_mfma_f32_16x16x32_bf16 v[200:203], a[44:47], a[80:83], v[200:203]
ds_read_b64_tr_b16 a[20:21], v25 offset:32768
v_mfma_f32_16x16x32_bf16 v[204:207], a[44:47], a[84:87], v[204:207]
ds_read_b64_tr_b16 a[22:23], v25 offset:33792
s_add_u32 s65, s57, s59
v_mfma_f32_16x16x32_bf16 v[208:211], a[48:51], a[76:79], v[208:211]
ds_read_b64_tr_b16 a[24:25], v26 offset:32768
v_mfma_f32_16x16x32_bf16 v[212:215], a[48:51], a[80:83], v[212:215]
ds_read_b64_tr_b16 a[26:27], v26 offset:33792
s_lshl_b32 s57, s26, 1
v_mfma_f32_16x16x32_bf16 v[216:219], a[48:51], a[84:87], v[216:219]
ds_read_b64_tr_b16 a[28:29], v27 offset:32768
buffer_load_dwordx4 v11, s[8:11], s52 offen offset:3072 lds
v_mfma_f32_16x16x32_bf16 v[220:223], a[52:55], a[76:79], v[220:223]
ds_read_b64_tr_b16 a[30:31], v27 offset:33792
s_add_u32 s57, s57, 2
v_mfma_f32_16x16x32_bf16 v[224:227], a[52:55], a[80:83], v[224:227]
ds_read_b64 a[96:97], v36 offset:0
v_mfma_f32_16x16x32_bf16 v[228:231], a[52:55], a[84:87], v[228:231]
ds_read_b64 a[98:99], v37 offset:0
s_add_u32 m0, s33, 12288
v_mfma_f32_16x16x32_bf16 v[232:235], a[56:59], a[76:79], v[232:235]
ds_read_b64 a[100:101], v38 offset:0
buffer_load_dwordx4 v12, s[4:7], s53 offen offset:0 lds
v_mfma_f32_16x16x32_bf16 v[236:239], a[56:59], a[80:83], v[236:239]
ds_read_b64 a[102:103], v39 offset:0
s_cmp_ge_u32 s57, 7
s_cselect_b32 s58, 7, 0
v_mfma_f32_16x16x32_bf16 v[240:243], a[56:59], a[84:87], v[240:243]
v_mfma_f32_16x16x32_bf16 v[244:247], a[60:63], a[76:79], v[244:247]
s_sub_u32 s57, s57, s58
v_mfma_f32_16x16x32_bf16 v[248:251], a[60:63], a[80:83], v[248:251]
v_mfma_f32_16x16x32_bf16 v[252:255], a[60:63], a[84:87], v[252:255]
s_add_u32 s57, s57, s25
s_waitcnt lgkmcnt(0)
v_mfma_f32_16x16x32_bf16 v[160:163], a[0:3], a[64:67], v[160:163]
ds_read_b128 a[76:79], v29 offset:0
ds_read_b128 a[80:83], v29 offset:2048
v_mfma_f32_16x16x32_bf16 v[164:167], a[0:3], a[68:71], v[164:167]
ds_read_b128 a[84:87], v29 offset:4096
ds_read_b64_tr_b16 a[32:33], v20 offset:40960
buffer_load_dwordx4 v13, s[4:7], s53 offen offset:1024 lds
v_mfma_f32_16x16x32_bf16 v[168:171], a[0:3], a[72:75], v[168:171]
ds_read_b64_tr_b16 a[34:35], v20 offset:41984
ds_read_b64_tr_b16 a[36:37], v21 offset:40960
s_add_u32 s55, s0, 8
v_mfma_f32_16x16x32_bf16 v[172:175], a[4:7], a[64:67], v[172:175]
ds_read_b64_tr_b16 a[38:39], v21 offset:41984
s_add_u32 s57, s57, 1
v_mfma_f32_16x16x32_bf16 v[176:179], a[4:7], a[68:71], v[176:179]
ds_read_b64_tr_b16 a[40:41], v22 offset:40960
s_and_b32 s55, s55, 15
v_mfma_f32_16x16x32_bf16 v[180:183], a[4:7], a[72:75], v[180:183]
ds_read_b64_tr_b16 a[42:43], v22 offset:41984
buffer_load_dwordx4 v14, s[4:7], s53 offen offset:2048 lds
v_mfma_f32_16x16x32_bf16 v[184:187], a[8:11], a[64:67], v[184:187]
ds_read_b64_tr_b16 a[44:45], v23 offset:40960
s_add_u32 s31, s55, s1
v_mfma_f32_16x16x32_bf16 v[188:191], a[8:11], a[68:71], v[188:191]
ds_read_b64_tr_b16 a[46:47], v23 offset:41984
s_and_b32 s57, s57, 7
v_mfma_f32_16x16x32_bf16 v[192:195], a[8:11], a[72:75], v[192:195]
ds_read_b64_tr_b16 a[48:49], v24 offset:40960
s_and_b32 s31, s31, 3
v_mfma_f32_16x16x32_bf16 v[196:199], a[12:15], a[64:67], v[196:199]
ds_read_b64_tr_b16 a[50:51], v24 offset:41984
buffer_load_dwordx4 v15, s[4:7], s53 offen offset:3072 lds
v_mfma_f32_16x16x32_bf16 v[200:203], a[12:15], a[68:71], v[200:203]
ds_read_b64_tr_b16 a[52:53], v25 offset:40960
s_and_b32 s55, s55, 12
v_mfma_f32_16x16x32_bf16 v[204:207], a[12:15], a[72:75], v[204:207]
ds_read_b64_tr_b16 a[54:55], v25 offset:41984
s_lshl_b32 s81, s57, 18
v_mfma_f32_16x16x32_bf16 v[208:211], a[16:19], a[64:67], v[208:211]
ds_read_b64_tr_b16 a[56:57], v26 offset:40960
s_or_b32 s55, s55, s31
v_mfma_f32_16x16x32_bf16 v[212:215], a[16:19], a[68:71], v[212:215]
ds_read_b64_tr_b16 a[58:59], v26 offset:41984
s_add_u32 m0, s33, 16384
v_mfma_f32_16x16x32_bf16 v[216:219], a[16:19], a[72:75], v[216:219]
ds_read_b64_tr_b16 a[60:61], v27 offset:40960
buffer_load_dwordx4 v16, s[4:7], s53 offen offset:0 lds
s_lshl_b32 s30, s55, 19
v_mfma_f32_16x16x32_bf16 v[220:223], a[20:23], a[64:67], v[220:223]
ds_read_b64_tr_b16 a[62:63], v27 offset:41984
s_mul_i32 s57, s57, 49152
v_mfma_f32_16x16x32_bf16 v[224:227], a[20:23], a[68:71], v[224:227]
ds_read_b64 a[104:105], v40 offset:0
s_lshl_b32 s31, s55, 7
v_mfma_f32_16x16x32_bf16 v[228:231], a[20:23], a[72:75], v[228:231]
ds_read_b64 a[106:107], v41 offset:0
s_add_u32 s57, s57, s56
v_mfma_f32_16x16x32_bf16 v[232:235], a[24:27], a[64:67], v[232:235]
ds_read_b64 a[108:109], v42 offset:0
buffer_load_dwordx4 v17, s[4:7], s53 offen offset:1024 lds
v_mfma_f32_16x16x32_bf16 v[236:239], a[24:27], a[68:71], v[236:239]
ds_read_b64 a[110:111], v43 offset:0
s_mul_i32 s59, s24, 3072
v_mfma_f32_16x16x32_bf16 v[240:243], a[24:27], a[72:75], v[240:243]
v_mfma_f32_16x16x32_bf16 v[244:247], a[28:31], a[64:67], v[244:247]
s_add_u32 s66, s57, s59
v_mfma_f32_16x16x32_bf16 v[248:251], a[28:31], a[68:71], v[248:251]
v_mfma_f32_16x16x32_bf16 v[252:255], a[28:31], a[72:75], v[252:255]
s_lshl_b32 s57, s26, 1
s_waitcnt vmcnt(10) lgkmcnt(0)
s_barrier
v_mfma_f32_16x16x32_bf16 v[160:163], a[32:35], a[76:79], v[160:163]
ds_read_b128 a[64:67], v28 offset:6144
s_add_u32 m0, s32, 32768
v_mfma_f32_16x16x32_bf16 v[164:167], a[32:35], a[80:83], v[164:167]
ds_read_b128 a[68:71], v28 offset:8192
buffer_load_dwordx4 v8, s[8:11], s30 offen offset:0 lds
v_mfma_f32_16x16x32_bf16 v[168:171], a[32:35], a[84:87], v[168:171]
ds_read_b128 a[72:75], v28 offset:10240
v_mfma_f32_16x16x32_bf16 v[172:175], a[36:39], a[76:79], v[172:175]
ds_read_b64_tr_b16 a[0:1], v20 offset:0
s_add_u32 s57, s57, 3
v_mfma_f32_16x16x32_bf16 v[176:179], a[36:39], a[80:83], v[176:179]
ds_read_b64_tr_b16 a[2:3], v20 offset:1024
buffer_load_dwordx4 v9, s[8:11], s30 offen offset:1024 lds
v_mfma_f32_16x16x32_bf16 v[180:183], a[36:39], a[84:87], v[180:183]
ds_read_b64_tr_b16 a[4:5], v21 offset:0
s_cmp_ge_u32 s57, 7
s_cselect_b32 s58, 7, 0
v_mfma_f32_16x16x32_bf16 v[184:187], a[40:43], a[76:79], v[184:187]
ds_read_b64_tr_b16 a[6:7], v21 offset:1024
v_mfma_f32_16x16x32_bf16 v[188:191], a[40:43], a[80:83], v[188:191]
ds_read_b64_tr_b16 a[8:9], v22 offset:0
buffer_load_dwordx4 v10, s[8:11], s30 offen offset:2048 lds
v_mfma_f32_16x16x32_bf16 v[192:195], a[40:43], a[84:87], v[192:195]
ds_read_b64_tr_b16 a[10:11], v22 offset:1024
v_mfma_f32_16x16x32_bf16 v[196:199], a[44:47], a[76:79], v[196:199]
ds_read_b64_tr_b16 a[12:13], v23 offset:0
s_sub_u32 s57, s57, s58
v_mfma_f32_16x16x32_bf16 v[200:203], a[44:47], a[80:83], v[200:203]
ds_read_b64_tr_b16 a[14:15], v23 offset:1024
buffer_load_dwordx4 v11, s[8:11], s30 offen offset:3072 lds
v_mfma_f32_16x16x32_bf16 v[204:207], a[44:47], a[84:87], v[204:207]
ds_read_b64_tr_b16 a[16:17], v24 offset:0
s_add_u32 s57, s57, s25
v_mfma_f32_16x16x32_bf16 v[208:211], a[48:51], a[76:79], v[208:211]
ds_read_b64_tr_b16 a[18:19], v24 offset:1024
s_add_u32 m0, s33, 22528
s_add_u32 s35, s38, 4096
v_mfma_f32_16x16x32_bf16 v[212:215], a[48:51], a[80:83], v[212:215]
ds_read_b64_tr_b16 a[20:21], v25 offset:0
buffer_load_dwordx4 v30, s[12:15], s35 offen offset:0 nt lds
v_mfma_f32_16x16x32_bf16 v[216:219], a[48:51], a[84:87], v[216:219]
ds_read_b64_tr_b16 a[22:23], v25 offset:1024
v_mfma_f32_16x16x32_bf16 v[220:223], a[52:55], a[76:79], v[220:223]
ds_read_b64_tr_b16 a[24:25], v26 offset:0
s_add_u32 s35, s38, 4096
v_mfma_f32_16x16x32_bf16 v[224:227], a[52:55], a[80:83], v[224:227]
ds_read_b64_tr_b16 a[26:27], v26 offset:1024
buffer_load_dwordx4 v31, s[12:15], s35 offen offset:1024 nt lds
v_mfma_f32_16x16x32_bf16 v[228:231], a[52:55], a[84:87], v[228:231]
ds_read_b64_tr_b16 a[28:29], v27 offset:0
s_add_u32 s57, s57, 1
v_mfma_f32_16x16x32_bf16 v[232:235], a[56:59], a[76:79], v[232:235]
ds_read_b64_tr_b16 a[30:31], v27 offset:1024
s_add_u32 m0, s33, 0
v_mfma_f32_16x16x32_bf16 v[236:239], a[56:59], a[80:83], v[236:239]
buffer_load_dwordx4 v12, s[4:7], s31 offen offset:0 lds
s_and_b32 s57, s57, 7
v_mfma_f32_16x16x32_bf16 v[240:243], a[56:59], a[84:87], v[240:243]
v_mfma_f32_16x16x32_bf16 v[244:247], a[60:63], a[76:79], v[244:247]
s_lshl_b32 s82, s57, 18
v_mfma_f32_16x16x32_bf16 v[248:251], a[60:63], a[80:83], v[248:251]
v_mfma_f32_16x16x32_bf16 v[252:255], a[60:63], a[84:87], v[252:255]
s_mul_i32 s57, s57, 49152
s_waitcnt lgkmcnt(0)
v_mfma_f32_16x16x32_bf16 v[160:163], a[0:3], a[64:67], v[160:163]
ds_read_b128 a[76:79], v29 offset:6144
v_mfma_f32_16x16x32_bf16 v[164:167], a[0:3], a[68:71], v[164:167]
ds_read_b128 a[80:83], v29 offset:8192
buffer_load_dwordx4 v13, s[4:7], s31 offen offset:1024 lds
v_mfma_f32_16x16x32_bf16 v[168:171], a[0:3], a[72:75], v[168:171]
ds_read_b128 a[84:87], v29 offset:10240
s_add_u32 s55, s0, 9
v_mfma_f32_16x16x32_bf16 v[172:175], a[4:7], a[64:67], v[172:175]
ds_read_b64_tr_b16 a[32:33], v20 offset:8192
s_add_u32 s57, s57, s56
v_mfma_f32_16x16x32_bf16 v[176:179], a[4:7], a[68:71], v[176:179]
ds_read_b64_tr_b16 a[34:35], v20 offset:9216
buffer_load_dwordx4 v14, s[4:7], s31 offen offset:2048 lds
s_and_b32 s55, s55, 15
v_mfma_f32_16x16x32_bf16 v[180:183], a[4:7], a[72:75], v[180:183]
ds_read_b64_tr_b16 a[36:37], v21 offset:8192
s_mul_i32 s59, s24, 3072
v_mfma_f32_16x16x32_bf16 v[184:187], a[8:11], a[64:67], v[184:187]
ds_read_b64_tr_b16 a[38:39], v21 offset:9216
s_add_u32 s53, s55, s1
v_mfma_f32_16x16x32_bf16 v[188:191], a[8:11], a[68:71], v[188:191]
ds_read_b64_tr_b16 a[40:41], v22 offset:8192
buffer_load_dwordx4 v15, s[4:7], s31 offen offset:3072 lds
v_mfma_f32_16x16x32_bf16 v[192:195], a[8:11], a[72:75], v[192:195]
ds_read_b64_tr_b16 a[42:43], v22 offset:9216
s_and_b32 s53, s53, 3
v_mfma_f32_16x16x32_bf16 v[196:199], a[12:15], a[64:67], v[196:199]
ds_read_b64_tr_b16 a[44:45], v23 offset:8192
s_add_u32 m0, s33, 22528
s_add_u32 s35, s38, 4096
v_mfma_f32_16x16x32_bf16 v[200:203], a[12:15], a[68:71], v[200:203]
ds_read_b64_tr_b16 a[46:47], v23 offset:9216
buffer_load_dwordx4 v32, s[12:15], s35 offen offset:2048 nt lds
s_and_b32 s55, s55, 12
v_mfma_f32_16x16x32_bf16 v[204:207], a[12:15], a[72:75], v[204:207]
ds_read_b64_tr_b16 a[48:49], v24 offset:8192
s_add_u32 s67, s57, s59
v_mfma_f32_16x16x32_bf16 v[208:211], a[16:19], a[64:67], v[208:211]
ds_read_b64_tr_b16 a[50:51], v24 offset:9216
s_add_u32 s35, s38, 4096
s_or_b32 s55, s55, s53
v_mfma_f32_16x16x32_bf16 v[212:215], a[16:19], a[68:71], v[212:215]
ds_read_b64_tr_b16 a[52:53], v25 offset:8192
buffer_load_dwordx4 v33, s[12:15], s35 offen offset:3072 nt lds
v_mfma_f32_16x16x32_bf16 v[216:219], a[16:19], a[72:75], v[216:219]
ds_read_b64_tr_b16 a[54:55], v25 offset:9216
s_lshl_b32 s52, s55, 19
v_mfma_f32_16x16x32_bf16 v[220:223], a[20:23], a[64:67], v[220:223]
ds_read_b64_tr_b16 a[56:57], v26 offset:8192
s_add_u32 m0, s33, 4096
v_mfma_f32_16x16x32_bf16 v[224:227], a[20:23], a[68:71], v[224:227]
ds_read_b64_tr_b16 a[58:59], v26 offset:9216
buffer_load_dwordx4 v16, s[4:7], s31 offen offset:0 lds
s_lshl_b32 s53, s55, 7
v_mfma_f32_16x16x32_bf16 v[228:231], a[20:23], a[72:75], v[228:231]
ds_read_b64_tr_b16 a[60:61], v27 offset:8192
s_lshl_b32 s57, s26, 1
v_mfma_f32_16x16x32_bf16 v[232:235], a[24:27], a[64:67], v[232:235]
ds_read_b64_tr_b16 a[62:63], v27 offset:9216
v_mfma_f32_16x16x32_bf16 v[236:239], a[24:27], a[68:71], v[236:239]
buffer_load_dwordx4 v17, s[4:7], s31 offen offset:1024 lds
s_add_u32 s57, s57, 4
v_mfma_f32_16x16x32_bf16 v[240:243], a[24:27], a[72:75], v[240:243]
v_mfma_f32_16x16x32_bf16 v[244:247], a[28:31], a[64:67], v[244:247]
s_cmp_ge_u32 s57, 7
s_cselect_b32 s58, 7, 0
v_mfma_f32_16x16x32_bf16 v[248:251], a[28:31], a[68:71], v[248:251]
v_mfma_f32_16x16x32_bf16 v[252:255], a[28:31], a[72:75], v[252:255]
s_sub_u32 s57, s57, s58
s_waitcnt vmcnt(14) lgkmcnt(0)
s_barrier
v_mfma_f32_16x16x32_bf16 v[160:163], a[32:35], a[76:79], v[160:163]
ds_read_b128 a[64:67], v28 offset:12288
s_add_u32 m0, s32, 0
v_mfma_f32_16x16x32_bf16 v[164:167], a[32:35], a[80:83], v[164:167]
ds_read_b128 a[68:71], v28 offset:14336
buffer_load_dwordx4 v8, s[8:11], s52 offen offset:0 lds
v_mfma_f32_16x16x32_bf16 v[168:171], a[32:35], a[84:87], v[168:171]
ds_read_b128 a[72:75], v28 offset:16384
v_mfma_f32_16x16x32_bf16 v[172:175], a[36:39], a[76:79], v[172:175]
ds_read_b64_tr_b16 a[0:1], v20 offset:16384
s_add_u32 s57, s57, s25
v_mfma_f32_16x16x32_bf16 v[176:179], a[36:39], a[80:83], v[176:179]
ds_read_b64_tr_b16 a[2:3], v20 offset:17408
v_mfma_f32_16x16x32_bf16 v[180:183], a[36:39], a[84:87], v[180:183]
ds_read_b64_tr_b16 a[4:5], v21 offset:16384
buffer_load_dwordx4 v9, s[8:11], s52 offen offset:1024 lds
v_mfma_f32_16x16x32_bf16 v[184:187], a[40:43], a[76:79], v[184:187]
ds_read_b64_tr_b16 a[6:7], v21 offset:17408
v_mfma_f32_16x16x32_bf16 v[188:191], a[40:43], a[80:83], v[188:191]
ds_read_b64_tr_b16 a[8:9], v22 offset:16384
s_add_u32 s57, s57, 1
v_mfma_f32_16x16x32_bf16 v[192:195], a[40:43], a[84:87], v[192:195]
ds_read_b64_tr_b16 a[10:11], v22 offset:17408
v_mfma_f32_16x16x32_bf16 v[196:199], a[44:47], a[76:79], v[196:199]
ds_read_b64_tr_b16 a[12:13], v23 offset:16384
buffer_load_dwordx4 v10, s[8:11], s52 offen offset:2048 lds
v_mfma_f32_16x16x32_bf16 v[200:203], a[44:47], a[80:83], v[200:203]
ds_read_b64_tr_b16 a[14:15], v23 offset:17408
v_mfma_f32_16x16x32_bf16 v[204:207], a[44:47], a[84:87], v[204:207]
ds_read_b64_tr_b16 a[16:17], v24 offset:16384
s_and_b32 s57, s57, 7
v_mfma_f32_16x16x32_bf16 v[208:211], a[48:51], a[76:79], v[208:211]
ds_read_b64_tr_b16 a[18:19], v24 offset:17408
v_mfma_f32_16x16x32_bf16 v[212:215], a[48:51], a[80:83], v[212:215]
ds_read_b64_tr_b16 a[20:21], v25 offset:16384
s_lshl_b32 s83, s57, 18
v_mfma_f32_16x16x32_bf16 v[216:219], a[48:51], a[84:87], v[216:219]
ds_read_b64_tr_b16 a[22:23], v25 offset:17408
buffer_load_dwordx4 v11, s[8:11], s52 offen offset:3072 lds
v_mfma_f32_16x16x32_bf16 v[220:223], a[52:55], a[76:79], v[220:223]
ds_read_b64_tr_b16 a[24:25], v26 offset:16384
s_mul_i32 s57, s57, 49152
v_mfma_f32_16x16x32_bf16 v[224:227], a[52:55], a[80:83], v[224:227]
ds_read_b64_tr_b16 a[26:27], v26 offset:17408
v_mfma_f32_16x16x32_bf16 v[228:231], a[52:55], a[84:87], v[228:231]
ds_read_b64_tr_b16 a[28:29], v27 offset:16384
s_add_u32 m0, s33, 6144
v_mfma_f32_16x16x32_bf16 v[232:235], a[56:59], a[76:79], v[232:235]
ds_read_b64_tr_b16 a[30:31], v27 offset:17408
buffer_load_dwordx4 v12, s[4:7], s53 offen offset:0 lds
v_mfma_f32_16x16x32_bf16 v[236:239], a[56:59], a[80:83], v[236:239]
s_add_u32 s57, s57, s56
v_mfma_f32_16x16x32_bf16 v[240:243], a[56:59], a[84:87], v[240:243]
v_mfma_f32_16x16x32_bf16 v[244:247], a[60:63], a[76:79], v[244:247]
s_mul_i32 s59, s24, 3072
v_mfma_f32_16x16x32_bf16 v[248:251], a[60:63], a[80:83], v[248:251]
v_mfma_f32_16x16x32_bf16 v[252:255], a[60:63], a[84:87], v[252:255]
s_add_u32 s68, s57, s59
s_waitcnt lgkmcnt(0)
v_mfma_f32_16x16x32_bf16 v[160:163], a[0:3], a[64:67], v[160:163]
ds_read_b128 a[76:79], v29 offset:12288
v_mfma_f32_16x16x32_bf16 v[164:167], a[0:3], a[68:71], v[164:167]
ds_read_b128 a[80:83], v29 offset:14336
buffer_load_dwordx4 v13, s[4:7], s53 offen offset:1024 lds
v_mfma_f32_16x16x32_bf16 v[168:171], a[0:3], a[72:75], v[168:171]
ds_read_b128 a[84:87], v29 offset:16384
s_add_u32 s55, s0, 10
v_mfma_f32_16x16x32_bf16 v[172:175], a[4:7], a[64:67], v[172:175]
ds_read_b64_tr_b16 a[32:33], v20 offset:24576
s_lshl_b32 s57, s26, 1
v_mfma_f32_16x16x32_bf16 v[176:179], a[4:7], a[68:71], v[176:179]
ds_read_b64_tr_b16 a[34:35], v20 offset:25600
s_and_b32 s55, s55, 15
v_mfma_f32_16x16x32_bf16 v[180:183], a[4:7], a[72:75], v[180:183]
ds_read_b64_tr_b16 a[36:37], v21 offset:24576
buffer_load_dwordx4 v14, s[4:7], s53 offen offset:2048 lds
v_mfma_f32_16x16x32_bf16 v[184:187], a[8:11], a[64:67], v[184:187]
ds_read_b64_tr_b16 a[38:39], v21 offset:25600
s_add_u32 s31, s55, s1
v_mfma_f32_16x16x32_bf16 v[188:191], a[8:11], a[68:71], v[188:191]
ds_read_b64_tr_b16 a[40:41], v22 offset:24576
s_add_u32 s57, s57, 5
v_mfma_f32_16x16x32_bf16 v[192:195], a[8:11], a[72:75], v[192:195]
ds_read_b64_tr_b16 a[42:43], v22 offset:25600
s_and_b32 s31, s31, 3
v_mfma_f32_16x16x32_bf16 v[196:199], a[12:15], a[64:67], v[196:199]
ds_read_b64_tr_b16 a[44:45], v23 offset:24576
buffer_load_dwordx4 v15, s[4:7], s53 offen offset:3072 lds
v_mfma_f32_16x16x32_bf16 v[200:203], a[12:15], a[68:71], v[200:203]
ds_read_b64_tr_b16 a[46:47], v23 offset:25600
s_and_b32 s55, s55, 12
v_mfma_f32_16x16x32_bf16 v[204:207], a[12:15], a[72:75], v[204:207]
ds_read_b64_tr_b16 a[48:49], v24 offset:24576
s_cmp_ge_u32 s57, 7
s_cselect_b32 s58, 7, 0
v_mfma_f32_16x16x32_bf16 v[208:211], a[16:19], a[64:67], v[208:211]
ds_read_b64_tr_b16 a[50:51], v24 offset:25600
s_or_b32 s55, s55, s31
v_mfma_f32_16x16x32_bf16 v[212:215], a[16:19], a[68:71], v[212:215]
ds_read_b64_tr_b16 a[52:53], v25 offset:24576
s_add_u32 m0, s33, 10240
v_mfma_f32_16x16x32_bf16 v[216:219], a[16:19], a[72:75], v[216:219]
ds_read_b64_tr_b16 a[54:55], v25 offset:25600
buffer_load_dwordx4 v16, s[4:7], s53 offen offset:0 lds
s_lshl_b32 s30, s55, 19
v_mfma_f32_16x16x32_bf16 v[220:223], a[20:23], a[64:67], v[220:223]
ds_read_b64_tr_b16 a[56:57], v26 offset:24576
s_sub_u32 s57, s57, s58
v_mfma_f32_16x16x32_bf16 v[224:227], a[20:23], a[68:71], v[224:227]
ds_read_b64_tr_b16 a[58:59], v26 offset:25600
s_lshl_b32 s31, s55, 7
v_mfma_f32_16x16x32_bf16 v[228:231], a[20:23], a[72:75], v[228:231]
ds_read_b64_tr_b16 a[60:61], v27 offset:24576
s_add_u32 s57, s57, s25
v_mfma_f32_16x16x32_bf16 v[232:235], a[24:27], a[64:67], v[232:235]
ds_read_b64_tr_b16 a[62:63], v27 offset:25600
buffer_load_dwordx4 v17, s[4:7], s53 offen offset:1024 lds
v_mfma_f32_16x16x32_bf16 v[236:239], a[24:27], a[68:71], v[236:239]
s_add_u32 s57, s57, 1
v_mfma_f32_16x16x32_bf16 v[240:243], a[24:27], a[72:75], v[240:243]
v_mfma_f32_16x16x32_bf16 v[244:247], a[28:31], a[64:67], v[244:247]
s_and_b32 s57, s57, 7
v_mfma_f32_16x16x32_bf16 v[248:251], a[28:31], a[68:71], v[248:251]
v_mfma_f32_16x16x32_bf16 v[252:255], a[28:31], a[72:75], v[252:255]
s_lshl_b32 s84, s57, 18
s_waitcnt vmcnt(10) lgkmcnt(0)
s_barrier
v_mfma_f32_16x16x32_bf16 v[160:163], a[32:35], a[76:79], v[160:163]
ds_read_b128 a[64:67], v28 offset:0
ds_read_b128 a[68:71], v28 offset:2048
s_add_u32 m0, s32, 16384
v_mfma_f32_16x16x32_bf16 v[164:167], a[32:35], a[80:83], v[164:167]
ds_read_b128 a[72:75], v28 offset:4096
ds_read_b64_tr_b16 a[0:1], v20 offset:32768
buffer_load_dwordx4 v8, s[8:11], s30 offen offset:0 lds
v_mfma_f32_16x16x32_bf16 v[168:171], a[32:35], a[84:87], v[168:171]
ds_read_b64_tr_b16 a[2:3], v20 offset:33792
ds_read_b64_tr_b16 a[4:5], v21 offset:32768
v_mfma_f32_16x16x32_bf16 v[172:175], a[36:39], a[76:79], v[172:175]
ds_read_b64_tr_b16 a[6:7], v21 offset:33792
s_mul_i32 s57, s57, 49152
v_mfma_f32_16x16x32_bf16 v[176:179], a[36:39], a[80:83], v[176:179]
ds_read_b64_tr_b16 a[8:9], v22 offset:32768
v_mfma_f32_16x16x32_bf16 v[180:183], a[36:39], a[84:87], v[180:183]
ds_read_b64_tr_b16 a[10:11], v22 offset:33792
buffer_load_dwordx4 v9, s[8:11], s30 offen offset:1024 lds
v_mfma_f32_16x16x32_bf16 v[184:187], a[40:43], a[76:79], v[184:187]
ds_read_b64_tr_b16 a[12:13], v23 offset:32768
v_mfma_f32_16x16x32_bf16 v[188:191], a[40:43], a[80:83], v[188:191]
ds_read_b64_tr_b16 a[14:15], v23 offset:33792
s_add_u32 s57, s57, s56
v_mfma_f32_16x16x32_bf16 v[192:195], a[40:43], a[84:87], v[192:195]
ds_read_b64_tr_b16 a[16:17], v24 offset:32768
v_mfma_f32_16x16x32_bf16 v[196:199], a[44:47], a[76:79], v[196:199]
ds_read_b64_tr_b16 a[18:19], v24 offset:33792
buffer_load_dwordx4 v10, s[8:11], s30 offen offset:2048 lds
v_mfma_f32_16x16x32_bf16 v[200:203], a[44:47], a[80:83], v[200:203]
ds_read_b64_tr_b16 a[20:21], v25 offset:32768
v_mfma_f32_16x16x32_bf16 v[204:207], a[44:47], a[84:87], v[204:207]
ds_read_b64_tr_b16 a[22:23], v25 offset:33792
s_mul_i32 s59, s24, 3072
v_mfma_f32_16x16x32_bf16 v[208:211], a[48:51], a[76:79], v[208:211]
ds_read_b64_tr_b16 a[24:25], v26 offset:32768
v_mfma_f32_16x16x32_bf16 v[212:215], a[48:51], a[80:83], v[212:215]
ds_read_b64_tr_b16 a[26:27], v26 offset:33792
s_add_u32 s69, s57, s59
v_mfma_f32_16x16x32_bf16 v[216:219], a[48:51], a[84:87], v[216:219]
ds_read_b64_tr_b16 a[28:29], v27 offset:32768
buffer_load_dwordx4 v11, s[8:11], s30 offen offset:3072 lds
v_mfma_f32_16x16x32_bf16 v[220:223], a[52:55], a[76:79], v[220:223]
ds_read_b64_tr_b16 a[30:31], v27 offset:33792
s_lshl_b32 s57, s26, 1
v_mfma_f32_16x16x32_bf16 v[224:227], a[52:55], a[80:83], v[224:227]
ds_read_b64 a[112:113], v36 offset:4096
v_mfma_f32_16x16x32_bf16 v[228:231], a[52:55], a[84:87], v[228:231]
ds_read_b64 a[114:115], v37 offset:4096
s_add_u32 m0, s33, 12288
v_mfma_f32_16x16x32_bf16 v[232:235], a[56:59], a[76:79], v[232:235]
ds_read_b64 a[116:117], v38 offset:4096
buffer_load_dwordx4 v12, s[4:7], s31 offen offset:0 lds
v_mfma_f32_16x16x32_bf16 v[236:239], a[56:59], a[80:83], v[236:239]
ds_read_b64 a[118:119], v39 offset:4096
s_add_u32 s57, s57, 6
v_mfma_f32_16x16x32_bf16 v[240:243], a[56:59], a[84:87], v[240:243]
v_mfma_f32_16x16x32_bf16 v[244:247], a[60:63], a[76:79], v[244:247]
s_cmp_ge_u32 s57, 7
s_cselect_b32 s58, 7, 0
v_mfma_f32_16x16x32_bf16 v[248:251], a[60:63], a[80:83], v[248:251]
v_mfma_f32_16x16x32_bf16 v[252:255], a[60:63], a[84:87], v[252:255]
s_sub_u32 s57, s57, s58
s_waitcnt lgkmcnt(0)
v_mfma_f32_16x16x32_bf16 v[160:163], a[0:3], a[64:67], v[160:163]
ds_read_b128 a[76:79], v29 offset:0
ds_read_b128 a[80:83], v29 offset:2048
v_mfma_f32_16x16x32_bf16 v[164:167], a[0:3], a[68:71], v[164:167]
ds_read_b128 a[84:87], v29 offset:4096
ds_read_b64_tr_b16 a[32:33], v20 offset:40960
buffer_load_dwordx4 v13, s[4:7], s31 offen offset:1024 lds
v_mfma_f32_16x16x32_bf16 v[168:171], a[0:3], a[72:75], v[168:171]
ds_read_b64_tr_b16 a[34:35], v20 offset:41984
ds_read_b64_tr_b16 a[36:37], v21 offset:40960
s_add_u32 s55, s0, 11
v_mfma_f32_16x16x32_bf16 v[172:175], a[4:7], a[64:67], v[172:175]
ds_read_b64_tr_b16 a[38:39], v21 offset:41984
s_add_u32 s57, s57, s25
v_mfma_f32_16x16x32_bf16 v[176:179], a[4:7], a[68:71], v[176:179]
ds_read_b64_tr_b16 a[40:41], v22 offset:40960
s_and_b32 s55, s55, 15
v_mfma_f32_16x16x32_bf16 v[180:183], a[4:7], a[72:75], v[180:183]
ds_read_b64_tr_b16 a[42:43], v22 offset:41984
buffer_load_dwordx4 v14, s[4:7], s31 offen offset:2048 lds
v_mfma_f32_16x16x32_bf16 v[184:187], a[8:11], a[64:67], v[184:187]
ds_read_b64_tr_b16 a[44:45], v23 offset:40960
s_add_u32 s53, s55, s1
v_mfma_f32_16x16x32_bf16 v[188:191], a[8:11], a[68:71], v[188:191]
ds_read_b64_tr_b16 a[46:47], v23 offset:41984
s_add_u32 s57, s57, 1
v_mfma_f32_16x16x32_bf16 v[192:195], a[8:11], a[72:75], v[192:195]
ds_read_b64_tr_b16 a[48:49], v24 offset:40960
s_and_b32 s53, s53, 3
v_mfma_f32_16x16x32_bf16 v[196:199], a[12:15], a[64:67], v[196:199]
ds_read_b64_tr_b16 a[50:51], v24 offset:41984
buffer_load_dwordx4 v15, s[4:7], s31 offen offset:3072 lds
v_mfma_f32_16x16x32_bf16 v[200:203], a[12:15], a[68:71], v[200:203]
ds_read_b64_tr_b16 a[52:53], v25 offset:40960
s_and_b32 s55, s55, 12
v_mfma_f32_16x16x32_bf16 v[204:207], a[12:15], a[72:75], v[204:207]
ds_read_b64_tr_b16 a[54:55], v25 offset:41984
s_and_b32 s57, s57, 7
v_mfma_f32_16x16x32_bf16 v[208:211], a[16:19], a[64:67], v[208:211]
ds_read_b64_tr_b16 a[56:57], v26 offset:40960
s_or_b32 s55, s55, s53
v_mfma_f32_16x16x32_bf16 v[212:215], a[16:19], a[68:71], v[212:215]
ds_read_b64_tr_b16 a[58:59], v26 offset:41984
s_add_u32 m0, s33, 16384
v_mfma_f32_16x16x32_bf16 v[216:219], a[16:19], a[72:75], v[216:219]
ds_read_b64_tr_b16 a[60:61], v27 offset:40960
buffer_load_dwordx4 v16, s[4:7], s31 offen offset:0 lds
s_lshl_b32 s52, s55, 19
v_mfma_f32_16x16x32_bf16 v[220:223], a[20:23], a[64:67], v[220:223]
ds_read_b64_tr_b16 a[62:63], v27 offset:41984
s_lshl_b32 s85, s57, 18
v_mfma_f32_16x16x32_bf16 v[224:227], a[20:23], a[68:71], v[224:227]
ds_read_b64 a[120:121], v40 offset:4096
s_lshl_b32 s53, s55, 7
v_mfma_f32_16x16x32_bf16 v[228:231], a[20:23], a[72:75], v[228:231]
ds_read_b64 a[122:123], v41 offset:4096
s_mul_i32 s57, s57, 49152
v_mfma_f32_16x16x32_bf16 v[232:235], a[24:27], a[64:67], v[232:235]
ds_read_b64 a[124:125], v42 offset:4096
buffer_load_dwordx4 v17, s[4:7], s31 offen offset:1024 lds
v_mfma_f32_16x16x32_bf16 v[236:239], a[24:27], a[68:71], v[236:239]
ds_read_b64 a[126:127], v43 offset:4096
s_add_u32 s57, s57, s56
v_mfma_f32_16x16x32_bf16 v[240:243], a[24:27], a[72:75], v[240:243]
v_mfma_f32_16x16x32_bf16 v[244:247], a[28:31], a[64:67], v[244:247]
s_mul_i32 s59, s24, 3072
v_mfma_f32_16x16x32_bf16 v[248:251], a[28:31], a[68:71], v[248:251]
v_mfma_f32_16x16x32_bf16 v[252:255], a[28:31], a[72:75], v[252:255]
s_add_u32 s70, s57, s59
s_waitcnt vmcnt(10) lgkmcnt(0)
s_barrier
v_mfma_f32_16x16x32_bf16 v[160:163], a[32:35], a[76:79], v[160:163]
ds_read_b128 a[64:67], v28 offset:6144
s_add_u32 m0, s32, 32768
v_mfma_f32_16x16x32_bf16 v[164:167], a[32:35], a[80:83], v[164:167]
ds_read_b128 a[68:71], v28 offset:8192
buffer_load_dwordx4 v8, s[8:11], s52 offen offset:0 lds
v_mfma_f32_16x16x32_bf16 v[168:171], a[32:35], a[84:87], v[168:171]
ds_read_b128 a[72:75], v28 offset:10240
v_mfma_f32_16x16x32_bf16 v[172:175], a[36:39], a[76:79], v[172:175]
ds_read_b64_tr_b16 a[0:1], v20 offset:0
s_mul_i32 s71, s24, 3072
v_mfma_f32_16x16x32_bf16 v[176:179], a[36:39], a[80:83], v[176:179]
ds_read_b64_tr_b16 a[2:3], v20 offset:1024
buffer_load_dwordx4 v9, s[8:11], s52 offen offset:1024 lds
v_mfma_f32_16x16x32_bf16 v[180:183], a[36:39], a[84:87], v[180:183]
ds_read_b64_tr_b16 a[4:5], v21 offset:0
s_add_u32 s57, s27, 1
v_mfma_f32_16x16x32_bf16 v[184:187], a[40:43], a[76:79], v[184:187]
ds_read_b64_tr_b16 a[6:7], v21 offset:1024
v_mfma_f32_16x16x32_bf16 v[188:191], a[40:43], a[80:83], v[188:191]
ds_read_b64_tr_b16 a[8:9], v22 offset:0
buffer_load_dwordx4 v10, s[8:11], s52 offen offset:2048 lds
v_mfma_f32_16x16x32_bf16 v[192:195], a[40:43], a[84:87], v[192:195]
ds_read_b64_tr_b16 a[10:11], v22 offset:1024
v_mfma_f32_16x16x32_bf16 v[196:199], a[44:47], a[76:79], v[196:199]
ds_read_b64_tr_b16 a[12:13], v23 offset:0
s_and_b32 s57, s57, 3
v_mfma_f32_16x16x32_bf16 v[200:203], a[44:47], a[80:83], v[200:203]
ds_read_b64_tr_b16 a[14:15], v23 offset:1024
buffer_load_dwordx4 v11, s[8:11], s52 offen offset:3072 lds
v_mfma_f32_16x16x32_bf16 v[204:207], a[44:47], a[84:87], v[204:207]
ds_read_b64_tr_b16 a[16:17], v24 offset:0
s_lshl_b32 s59, s37, 2
v_mfma_f32_16x16x32_bf16 v[208:211], a[48:51], a[76:79], v[208:211]
ds_read_b64_tr_b16 a[18:19], v24 offset:1024
s_add_u32 m0, s33, 18432
s_add_u32 s35, s38, 8192
v_mfma_f32_16x16x32_bf16 v[212:215], a[48:51], a[80:83], v[212:215]
ds_read_b64_tr_b16 a[20:21], v25 offset:0
buffer_load_dwordx4 v30, s[12:15], s35 offen offset:0 nt lds
v_mfma_f32_16x16x32_bf16 v[216:219], a[48:51], a[84:87], v[216:219]
ds_read_b64_tr_b16 a[22:23], v25 offset:1024
v_mfma_f32_16x16x32_bf16 v[220:223], a[52:55], a[76:79], v[220:223]
ds_read_b64_tr_b16 a[24:25], v26 offset:0
s_add_u32 s35, s38, 8192
v_mfma_f32_16x16x32_bf16 v[224:227], a[52:55], a[80:83], v[224:227]
ds_read_b64_tr_b16 a[26:27], v26 offset:1024
buffer_load_dwordx4 v31, s[12:15], s35 offen offset:1024 nt lds
v_mfma_f32_16x16x32_bf16 v[228:231], a[52:55], a[84:87], v[228:231]
ds_read_b64_tr_b16 a[28:29], v27 offset:0
s_add_u32 s57, s57, s59
v_mfma_f32_16x16x32_bf16 v[232:235], a[56:59], a[76:79], v[232:235]
ds_read_b64_tr_b16 a[30:31], v27 offset:1024
s_add_u32 m0, s33, 0
v_mfma_f32_16x16x32_bf16 v[236:239], a[56:59], a[80:83], v[236:239]
buffer_load_dwordx4 v12, s[4:7], s53 offen offset:0 lds
s_mul_i32 s59, s57, 36864
v_mfma_f32_16x16x32_bf16 v[240:243], a[56:59], a[84:87], v[240:243]
v_mfma_f32_16x16x32_bf16 v[244:247], a[60:63], a[76:79], v[244:247]
s_add_u32 s59, s59, 213913600
v_mfma_f32_16x16x32_bf16 v[248:251], a[60:63], a[80:83], v[248:251]
v_mfma_f32_16x16x32_bf16 v[252:255], a[60:63], a[84:87], v[252:255]
s_lshl_b32 s72, s24, 10
s_waitcnt lgkmcnt(0)
v_mfma_f32_16x16x32_bf16 v[160:163], a[0:3], a[64:67], v[160:163]
ds_read_b128 a[76:79], v29 offset:6144
v_mfma_f32_16x16x32_bf16 v[164:167], a[0:3], a[68:71], v[164:167]
ds_read_b128 a[80:83], v29 offset:8192
buffer_load_dwordx4 v13, s[4:7], s53 offen offset:1024 lds
v_mfma_f32_16x16x32_bf16 v[168:171], a[0:3], a[72:75], v[168:171]
ds_read_b128 a[84:87], v29 offset:10240
s_add_u32 s55, s0, 12
v_mfma_f32_16x16x32_bf16 v[172:175], a[4:7], a[64:67], v[172:175]
ds_read_b64_tr_b16 a[32:33], v20 offset:8192
s_add_u32 s72, s72, s59
v_mfma_f32_16x16x32_bf16 v[176:179], a[4:7], a[68:71], v[176:179]
ds_read_b64_tr_b16 a[34:35], v20 offset:9216
buffer_load_dwordx4 v14, s[4:7], s53 offen offset:2048 lds
s_and_b32 s55, s55, 15
v_mfma_f32_16x16x32_bf16 v[180:183], a[4:7], a[72:75], v[180:183]
ds_read_b64_tr_b16 a[36:37], v21 offset:8192
s_lshl_b32 s57, s57, 2
v_mfma_f32_16x16x32_bf16 v[184:187], a[8:11], a[64:67], v[184:187]
ds_read_b64_tr_b16 a[38:39], v21 offset:9216
s_add_u32 s31, s55, s1
v_mfma_f32_16x16x32_bf16 v[188:191], a[8:11], a[68:71], v[188:191]
ds_read_b64_tr_b16 a[40:41], v22 offset:8192
buffer_load_dwordx4 v15, s[4:7], s53 offen offset:3072 lds
v_mfma_f32_16x16x32_bf16 v[192:195], a[8:11], a[72:75], v[192:195]
ds_read_b64_tr_b16 a[42:43], v22 offset:9216
s_and_b32 s31, s31, 3
v_mfma_f32_16x16x32_bf16 v[196:199], a[12:15], a[64:67], v[196:199]
ds_read_b64_tr_b16 a[44:45], v23 offset:8192
s_add_u32 m0, s33, 18432
s_add_u32 s35, s38, 8192
v_mfma_f32_16x16x32_bf16 v[200:203], a[12:15], a[68:71], v[200:203]
ds_read_b64_tr_b16 a[46:47], v23 offset:9216
buffer_load_dwordx4 v32, s[12:15], s35 offen offset:2048 nt lds
s_and_b32 s55, s55, 12
v_mfma_f32_16x16x32_bf16 v[204:207], a[12:15], a[72:75], v[204:207]
ds_read_b64_tr_b16 a[48:49], v24 offset:8192
s_add_u32 s57, s57, s24
v_mfma_f32_16x16x32_bf16 v[208:211], a[16:19], a[64:67], v[208:211]
ds_read_b64_tr_b16 a[50:51], v24 offset:9216
s_add_u32 s35, s38, 8192
s_or_b32 s55, s55, s31
v_mfma_f32_16x16x32_bf16 v[212:215], a[16:19], a[68:71], v[212:215]
ds_read_b64_tr_b16 a[52:53], v25 offset:8192
buffer_load_dwordx4 v33, s[12:15], s35 offen offset:3072 nt lds
v_mfma_f32_16x16x32_bf16 v[216:219], a[16:19], a[72:75], v[216:219]
ds_read_b64_tr_b16 a[54:55], v25 offset:9216
s_lshl_b32 s30, s55, 19
v_mfma_f32_16x16x32_bf16 v[220:223], a[20:23], a[64:67], v[220:223]
ds_read_b64_tr_b16 a[56:57], v26 offset:8192
s_add_u32 m0, s33, 4096
v_mfma_f32_16x16x32_bf16 v[224:227], a[20:23], a[68:71], v[224:227]
ds_read_b64_tr_b16 a[58:59], v26 offset:9216
buffer_load_dwordx4 v16, s[4:7], s53 offen offset:0 lds
s_lshl_b32 s31, s55, 7
v_mfma_f32_16x16x32_bf16 v[228:231], a[20:23], a[72:75], v[228:231]
ds_read_b64_tr_b16 a[60:61], v27 offset:8192
s_mul_i32 s57, s57, 32
v_mfma_f32_16x16x32_bf16 v[232:235], a[24:27], a[64:67], v[232:235]
ds_read_b64_tr_b16 a[62:63], v27 offset:9216
v_mfma_f32_16x16x32_bf16 v[236:239], a[24:27], a[68:71], v[236:239]
buffer_load_dwordx4 v17, s[4:7], s53 offen offset:1024 lds
s_add_u32 s75, s57, 223358976
v_mfma_f32_16x16x32_bf16 v[240:243], a[24:27], a[72:75], v[240:243]
v_mfma_f32_16x16x32_bf16 v[244:247], a[28:31], a[64:67], v[244:247]
s_add_u32 s57, s27, 2
v_mfma_f32_16x16x32_bf16 v[248:251], a[28:31], a[68:71], v[248:251]
v_mfma_f32_16x16x32_bf16 v[252:255], a[28:31], a[72:75], v[252:255]
s_and_b32 s57, s57, 3
s_waitcnt vmcnt(14) lgkmcnt(0)
s_barrier
v_mfma_f32_16x16x32_bf16 v[160:163], a[32:35], a[76:79], v[160:163]
ds_read_b128 a[64:67], v28 offset:12288
s_add_u32 m0, s32, 0
v_mfma_f32_16x16x32_bf16 v[164:167], a[32:35], a[80:83], v[164:167]
ds_read_b128 a[68:71], v28 offset:14336
buffer_load_dwordx4 v8, s[8:11], s30 offen offset:0 lds
v_mfma_f32_16x16x32_bf16 v[168:171], a[32:35], a[84:87], v[168:171]
ds_read_b128 a[72:75], v28 offset:16384
v_mfma_f32_16x16x32_bf16 v[172:175], a[36:39], a[76:79], v[172:175]
ds_read_b64_tr_b16 a[0:1], v20 offset:16384
s_lshl_b32 s59, s37, 2
v_mfma_f32_16x16x32_bf16 v[176:179], a[36:39], a[80:83], v[176:179]
ds_read_b64_tr_b16 a[2:3], v20 offset:17408
v_mfma_f32_16x16x32_bf16 v[180:183], a[36:39], a[84:87], v[180:183]
ds_read_b64_tr_b16 a[4:5], v21 offset:16384
buffer_load_dwordx4 v9, s[8:11], s30 offen offset:1024 lds
v_mfma_f32_16x16x32_bf16 v[184:187], a[40:43], a[76:79], v[184:187]
ds_read_b64_tr_b16 a[6:7], v21 offset:17408
v_mfma_f32_16x16x32_bf16 v[188:191], a[40:43], a[80:83], v[188:191]
ds_read_b64_tr_b16 a[8:9], v22 offset:16384
s_add_u32 s57, s57, s59
v_mfma_f32_16x16x32_bf16 v[192:195], a[40:43], a[84:87], v[192:195]
ds_read_b64_tr_b16 a[10:11], v22 offset:17408
v_mfma_f32_16x16x32_bf16 v[196:199], a[44:47], a[76:79], v[196:199]
ds_read_b64_tr_b16 a[12:13], v23 offset:16384
buffer_load_dwordx4 v10, s[8:11], s30 offen offset:2048 lds
v_mfma_f32_16x16x32_bf16 v[200:203], a[44:47], a[80:83], v[200:203]
ds_read_b64_tr_b16 a[14:15], v23 offset:17408
v_mfma_f32_16x16x32_bf16 v[204:207], a[44:47], a[84:87], v[204:207]
ds_read_b64_tr_b16 a[16:17], v24 offset:16384
s_mul_i32 s59, s57, 36864
v_mfma_f32_16x16x32_bf16 v[208:211], a[48:51], a[76:79], v[208:211]
ds_read_b64_tr_b16 a[18:19], v24 offset:17408
v_mfma_f32_16x16x32_bf16 v[212:215], a[48:51], a[80:83], v[212:215]
ds_read_b64_tr_b16 a[20:21], v25 offset:16384
s_add_u32 s59, s59, 213913600
v_mfma_f32_16x16x32_bf16 v[216:219], a[48:51], a[84:87], v[216:219]
ds_read_b64_tr_b16 a[22:23], v25 offset:17408
buffer_load_dwordx4 v11, s[8:11], s30 offen offset:3072 lds
v_mfma_f32_16x16x32_bf16 v[220:223], a[52:55], a[76:79], v[220:223]
ds_read_b64_tr_b16 a[24:25], v26 offset:16384
s_lshl_b32 s73, s24, 10
v_mfma_f32_16x16x32_bf16 v[224:227], a[52:55], a[80:83], v[224:227]
ds_read_b64_tr_b16 a[26:27], v26 offset:17408
v_mfma_f32_16x16x32_bf16 v[228:231], a[52:55], a[84:87], v[228:231]
ds_read_b64_tr_b16 a[28:29], v27 offset:16384
s_add_u32 m0, s33, 6144
v_mfma_f32_16x16x32_bf16 v[232:235], a[56:59], a[76:79], v[232:235]
ds_read_b64_tr_b16 a[30:31], v27 offset:17408
buffer_load_dwordx4 v12, s[4:7], s31 offen offset:0 lds
v_mfma_f32_16x16x32_bf16 v[236:239], a[56:59], a[80:83], v[236:239]
s_add_u32 s73, s73, s59
v_mfma_f32_16x16x32_bf16 v[240:243], a[56:59], a[84:87], v[240:243]
v_mfma_f32_16x16x32_bf16 v[244:247], a[60:63], a[76:79], v[244:247]
s_lshl_b32 s57, s57, 2
v_mfma_f32_16x16x32_bf16 v[248:251], a[60:63], a[80:83], v[248:251]
v_mfma_f32_16x16x32_bf16 v[252:255], a[60:63], a[84:87], v[252:255]
s_add_u32 s57, s57, s24
s_waitcnt lgkmcnt(0)
v_mfma_f32_16x16x32_bf16 v[160:163], a[0:3], a[64:67], v[160:163]
ds_read_b128 a[76:79], v29 offset:12288
v_mfma_f32_16x16x32_bf16 v[164:167], a[0:3], a[68:71], v[164:167]
ds_read_b128 a[80:83], v29 offset:14336
buffer_load_dwordx4 v13, s[4:7], s31 offen offset:1024 lds
v_mfma_f32_16x16x32_bf16 v[168:171], a[0:3], a[72:75], v[168:171]
ds_read_b128 a[84:87], v29 offset:16384
s_add_u32 s55, s0, 13
v_mfma_f32_16x16x32_bf16 v[172:175], a[4:7], a[64:67], v[172:175]
ds_read_b64_tr_b16 a[32:33], v20 offset:24576
s_mul_i32 s57, s57, 32
v_mfma_f32_16x16x32_bf16 v[176:179], a[4:7], a[68:71], v[176:179]
ds_read_b64_tr_b16 a[34:35], v20 offset:25600
s_and_b32 s55, s55, 15
v_mfma_f32_16x16x32_bf16 v[180:183], a[4:7], a[72:75], v[180:183]
ds_read_b64_tr_b16 a[36:37], v21 offset:24576
buffer_load_dwordx4 v14, s[4:7], s31 offen offset:2048 lds
v_mfma_f32_16x16x32_bf16 v[184:187], a[8:11], a[64:67], v[184:187]
ds_read_b64_tr_b16 a[38:39], v21 offset:25600
s_add_u32 s53, s55, s1
v_mfma_f32_16x16x32_bf16 v[188:191], a[8:11], a[68:71], v[188:191]
ds_read_b64_tr_b16 a[40:41], v22 offset:24576
s_add_u32 s76, s57, 223358984
v_mfma_f32_16x16x32_bf16 v[192:195], a[8:11], a[72:75], v[192:195]
ds_read_b64_tr_b16 a[42:43], v22 offset:25600
s_and_b32 s53, s53, 3
v_mfma_f32_16x16x32_bf16 v[196:199], a[12:15], a[64:67], v[196:199]
ds_read_b64_tr_b16 a[44:45], v23 offset:24576
buffer_load_dwordx4 v15, s[4:7], s31 offen offset:3072 lds
v_mfma_f32_16x16x32_bf16 v[200:203], a[12:15], a[68:71], v[200:203]
ds_read_b64_tr_b16 a[46:47], v23 offset:25600
s_and_b32 s55, s55, 12
v_mfma_f32_16x16x32_bf16 v[204:207], a[12:15], a[72:75], v[204:207]
ds_read_b64_tr_b16 a[48:49], v24 offset:24576
s_add_u32 s57, s27, 3
v_mfma_f32_16x16x32_bf16 v[208:211], a[16:19], a[64:67], v[208:211]
ds_read_b64_tr_b16 a[50:51], v24 offset:25600
s_or_b32 s55, s55, s53
v_mfma_f32_16x16x32_bf16 v[212:215], a[16:19], a[68:71], v[212:215]
ds_read_b64_tr_b16 a[52:53], v25 offset:24576
s_add_u32 m0, s33, 10240
v_mfma_f32_16x16x32_bf16 v[216:219], a[16:19], a[72:75], v[216:219]
ds_read_b64_tr_b16 a[54:55], v25 offset:25600
buffer_load_dwordx4 v16, s[4:7], s31 offen offset:0 lds
s_lshl_b32 s52, s55, 19
v_mfma_f32_16x16x32_bf16 v[220:223], a[20:23], a[64:67], v[220:223]
ds_read_b64_tr_b16 a[56:57], v26 offset:24576
s_and_b32 s57, s57, 3
v_mfma_f32_16x16x32_bf16 v[224:227], a[20:23], a[68:71], v[224:227]
ds_read_b64_tr_b16 a[58:59], v26 offset:25600
s_lshl_b32 s53, s55, 7
v_mfma_f32_16x16x32_bf16 v[228:231], a[20:23], a[72:75], v[228:231]
ds_read_b64_tr_b16 a[60:61], v27 offset:24576
s_lshl_b32 s59, s37, 2
v_mfma_f32_16x16x32_bf16 v[232:235], a[24:27], a[64:67], v[232:235]
ds_read_b64_tr_b16 a[62:63], v27 offset:25600
buffer_load_dwordx4 v17, s[4:7], s31 offen offset:1024 lds
v_mfma_f32_16x16x32_bf16 v[236:239], a[24:27], a[68:71], v[236:239]
s_add_u32 s57, s57, s59
v_mfma_f32_16x16x32_bf16 v[240:243], a[24:27], a[72:75], v[240:243]
v_mfma_f32_16x16x32_bf16 v[244:247], a[28:31], a[64:67], v[244:247]
s_mul_i32 s59, s57, 36864
v_mfma_f32_16x16x32_bf16 v[248:251], a[28:31], a[68:71], v[248:251]
v_mfma_f32_16x16x32_bf16 v[252:255], a[28:31], a[72:75], v[252:255]
s_add_u32 s59, s59, 213913600
s_waitcnt vmcnt(10) lgkmcnt(0)
s_barrier
v_mfma_f32_16x16x32_bf16 v[160:163], a[32:35], a[76:79], v[160:163]
ds_read_b128 a[64:67], v28 offset:0
ds_read_b128 a[68:71], v28 offset:2048
s_add_u32 m0, s32, 16384
v_mfma_f32_16x16x32_bf16 v[164:167], a[32:35], a[80:83], v[164:167]
ds_read_b128 a[72:75], v28 offset:4096
ds_read_b64_tr_b16 a[0:1], v20 offset:32768
buffer_load_dwordx4 v8, s[8:11], s52 offen offset:0 lds
v_mfma_f32_16x16x32_bf16 v[168:171], a[32:35], a[84:87], v[168:171]
ds_read_b64_tr_b16 a[2:3], v20 offset:33792
ds_read_b64_tr_b16 a[4:5], v21 offset:32768
v_mfma_f32_16x16x32_bf16 v[172:175], a[36:39], a[76:79], v[172:175]
ds_read_b64_tr_b16 a[6:7], v21 offset:33792
s_lshl_b32 s74, s24, 10
v_mfma_f32_16x16x32_bf16 v[176:179], a[36:39], a[80:83], v[176:179]
ds_read_b64_tr_b16 a[8:9], v22 offset:32768
v_mfma_f32_16x16x32_bf16 v[180:183], a[36:39], a[84:87], v[180:183]
ds_read_b64_tr_b16 a[10:11], v22 offset:33792
buffer_load_dwordx4 v9, s[8:11], s52 offen offset:1024 lds
v_mfma_f32_16x16x32_bf16 v[184:187], a[40:43], a[76:79], v[184:187]
ds_read_b64_tr_b16 a[12:13], v23 offset:32768
v_mfma_f32_16x16x32_bf16 v[188:191], a[40:43], a[80:83], v[188:191]
ds_read_b64_tr_b16 a[14:15], v23 offset:33792
s_add_u32 s74, s74, s59
v_mfma_f32_16x16x32_bf16 v[192:195], a[40:43], a[84:87], v[192:195]
ds_read_b64_tr_b16 a[16:17], v24 offset:32768
v_mfma_f32_16x16x32_bf16 v[196:199], a[44:47], a[76:79], v[196:199]
ds_read_b64_tr_b16 a[18:19], v24 offset:33792
buffer_load_dwordx4 v10, s[8:11], s52 offen offset:2048 lds
v_mfma_f32_16x16x32_bf16 v[200:203], a[44:47], a[80:83], v[200:203]
ds_read_b64_tr_b16 a[20:21], v25 offset:32768
v_mfma_f32_16x16x32_bf16 v[204:207], a[44:47], a[84:87], v[204:207]
ds_read_b64_tr_b16 a[22:23], v25 offset:33792
s_lshl_b32 s57, s57, 2
v_mfma_f32_16x16x32_bf16 v[208:211], a[48:51], a[76:79], v[208:211]
ds_read_b64_tr_b16 a[24:25], v26 offset:32768
v_mfma_f32_16x16x32_bf16 v[212:215], a[48:51], a[80:83], v[212:215]
ds_read_b64_tr_b16 a[26:27], v26 offset:33792
s_add_u32 s57, s57, s24
v_mfma_f32_16x16x32_bf16 v[216:219], a[48:51], a[84:87], v[216:219]
ds_read_b64_tr_b16 a[28:29], v27 offset:32768
buffer_load_dwordx4 v11, s[8:11], s52 offen offset:3072 lds
v_mfma_f32_16x16x32_bf16 v[220:223], a[52:55], a[76:79], v[220:223]
ds_read_b64_tr_b16 a[30:31], v27 offset:33792
s_mul_i32 s57, s57, 32
v_mfma_f32_16x16x32_bf16 v[224:227], a[52:55], a[80:83], v[224:227]
ds_read_b64 a[128:129], v36 offset:0
v_mfma_f32_16x16x32_bf16 v[228:231], a[52:55], a[84:87], v[228:231]
ds_read_b64 a[130:131], v37 offset:0
s_add_u32 m0, s33, 12288
v_mfma_f32_16x16x32_bf16 v[232:235], a[56:59], a[76:79], v[232:235]
ds_read_b64 a[132:133], v38 offset:0
buffer_load_dwordx4 v12, s[4:7], s53 offen offset:0 lds
v_mfma_f32_16x16x32_bf16 v[236:239], a[56:59], a[80:83], v[236:239]
ds_read_b64 a[134:135], v39 offset:0
s_add_u32 s77, s57, 223358992
v_mfma_f32_16x16x32_bf16 v[240:243], a[56:59], a[84:87], v[240:243]
v_mfma_f32_16x16x32_bf16 v[244:247], a[60:63], a[76:79], v[244:247]
v_mfma_f32_16x16x32_bf16 v[248:251], a[60:63], a[80:83], v[248:251]
v_mfma_f32_16x16x32_bf16 v[252:255], a[60:63], a[84:87], v[252:255]
s_waitcnt lgkmcnt(0)
v_mfma_f32_16x16x32_bf16 v[160:163], a[0:3], a[64:67], v[160:163]
ds_read_b128 a[76:79], v29 offset:0
ds_read_b128 a[80:83], v29 offset:2048
v_mfma_f32_16x16x32_bf16 v[164:167], a[0:3], a[68:71], v[164:167]
ds_read_b128 a[84:87], v29 offset:4096
ds_read_b64_tr_b16 a[32:33], v20 offset:40960
buffer_load_dwordx4 v13, s[4:7], s53 offen offset:1024 lds
v_mfma_f32_16x16x32_bf16 v[168:171], a[0:3], a[72:75], v[168:171]
ds_read_b64_tr_b16 a[34:35], v20 offset:41984
ds_read_b64_tr_b16 a[36:37], v21 offset:40960
s_add_u32 s55, s0, 14
v_mfma_f32_16x16x32_bf16 v[172:175], a[4:7], a[64:67], v[172:175]
ds_read_b64_tr_b16 a[38:39], v21 offset:41984
v_mfma_f32_16x16x32_bf16 v[176:179], a[4:7], a[68:71], v[176:179]
ds_read_b64_tr_b16 a[40:41], v22 offset:40960
s_and_b32 s55, s55, 15
v_mfma_f32_16x16x32_bf16 v[180:183], a[4:7], a[72:75], v[180:183]
ds_read_b64_tr_b16 a[42:43], v22 offset:41984
buffer_load_dwordx4 v14, s[4:7], s53 offen offset:2048 lds
v_mfma_f32_16x16x32_bf16 v[184:187], a[8:11], a[64:67], v[184:187]
ds_read_b64_tr_b16 a[44:45], v23 offset:40960
s_add_u32 s31, s55, s1
v_mfma_f32_16x16x32_bf16 v[188:191], a[8:11], a[68:71], v[188:191]
ds_read_b64_tr_b16 a[46:47], v23 offset:41984
v_mfma_f32_16x16x32_bf16 v[192:195], a[8:11], a[72:75], v[192:195]
ds_read_b64_tr_b16 a[48:49], v24 offset:40960
s_and_b32 s31, s31, 3
v_mfma_f32_16x16x32_bf16 v[196:199], a[12:15], a[64:67], v[196:199]
ds_read_b64_tr_b16 a[50:51], v24 offset:41984
buffer_load_dwordx4 v15, s[4:7], s53 offen offset:3072 lds
v_mfma_f32_16x16x32_bf16 v[200:203], a[12:15], a[68:71], v[200:203]
ds_read_b64_tr_b16 a[52:53], v25 offset:40960
s_and_b32 s55, s55, 12
v_mfma_f32_16x16x32_bf16 v[204:207], a[12:15], a[72:75], v[204:207]
ds_read_b64_tr_b16 a[54:55], v25 offset:41984
v_mfma_f32_16x16x32_bf16 v[208:211], a[16:19], a[64:67], v[208:211]
ds_read_b64_tr_b16 a[56:57], v26 offset:40960
s_or_b32 s55, s55, s31
v_mfma_f32_16x16x32_bf16 v[212:215], a[16:19], a[68:71], v[212:215]
ds_read_b64_tr_b16 a[58:59], v26 offset:41984
s_add_u32 m0, s33, 16384
v_mfma_f32_16x16x32_bf16 v[216:219], a[16:19], a[72:75], v[216:219]
ds_read_b64_tr_b16 a[60:61], v27 offset:40960
buffer_load_dwordx4 v16, s[4:7], s53 offen offset:0 lds
s_lshl_b32 s30, s55, 19
v_mfma_f32_16x16x32_bf16 v[220:223], a[20:23], a[64:67], v[220:223]
ds_read_b64_tr_b16 a[62:63], v27 offset:41984
v_mfma_f32_16x16x32_bf16 v[224:227], a[20:23], a[68:71], v[224:227]
ds_read_b64 a[136:137], v40 offset:0
s_lshl_b32 s31, s55, 7
v_mfma_f32_16x16x32_bf16 v[228:231], a[20:23], a[72:75], v[228:231]
ds_read_b64 a[138:139], v41 offset:0
v_mfma_f32_16x16x32_bf16 v[232:235], a[24:27], a[64:67], v[232:235]
ds_read_b64 a[140:141], v42 offset:0
buffer_load_dwordx4 v17, s[4:7], s53 offen offset:1024 lds
v_mfma_f32_16x16x32_bf16 v[236:239], a[24:27], a[68:71], v[236:239]
ds_read_b64 a[142:143], v43 offset:0
v_mfma_f32_16x16x32_bf16 v[240:243], a[24:27], a[72:75], v[240:243]
v_mfma_f32_16x16x32_bf16 v[244:247], a[28:31], a[64:67], v[244:247]
v_mfma_f32_16x16x32_bf16 v[248:251], a[28:31], a[68:71], v[248:251]
v_mfma_f32_16x16x32_bf16 v[252:255], a[28:31], a[72:75], v[252:255]
s_waitcnt vmcnt(10) lgkmcnt(0)
s_barrier
v_mfma_f32_16x16x32_bf16 v[160:163], a[32:35], a[76:79], v[160:163]
ds_read_b128 a[64:67], v28 offset:6144
s_add_u32 m0, s32, 32768
v_mfma_f32_16x16x32_bf16 v[164:167], a[32:35], a[80:83], v[164:167]
ds_read_b128 a[68:71], v28 offset:8192
buffer_load_dwordx4 v8, s[8:11], s30 offen offset:0 lds
v_mfma_f32_16x16x32_bf16 v[168:171], a[32:35], a[84:87], v[168:171]
ds_read_b128 a[72:75], v28 offset:10240
v_mfma_f32_16x16x32_bf16 v[172:175], a[36:39], a[76:79], v[172:175]
ds_read_b64_tr_b16 a[0:1], v20 offset:0
v_mfma_f32_16x16x32_bf16 v[176:179], a[36:39], a[80:83], v[176:179]
ds_read_b64_tr_b16 a[2:3], v20 offset:1024
v_mfma_f32_16x16x32_bf16 v[180:183], a[36:39], a[84:87], v[180:183]
ds_read_b64_tr_b16 a[4:5], v21 offset:0
buffer_load_dwordx4 v9, s[8:11], s30 offen offset:1024 lds
v_mfma_f32_16x16x32_bf16 v[184:187], a[40:43], a[76:79], v[184:187]
ds_read_b64_tr_b16 a[6:7], v21 offset:1024
v_mfma_f32_16x16x32_bf16 v[188:191], a[40:43], a[80:83], v[188:191]
ds_read_b64_tr_b16 a[8:9], v22 offset:0
v_mfma_f32_16x16x32_bf16 v[192:195], a[40:43], a[84:87], v[192:195]
ds_read_b64_tr_b16 a[10:11], v22 offset:1024
v_mfma_f32_16x16x32_bf16 v[196:199], a[44:47], a[76:79], v[196:199]
ds_read_b64_tr_b16 a[12:13], v23 offset:0
buffer_load_dwordx4 v10, s[8:11], s30 offen offset:2048 lds
v_mfma_f32_16x16x32_bf16 v[200:203], a[44:47], a[80:83], v[200:203]
ds_read_b64_tr_b16 a[14:15], v23 offset:1024
v_mfma_f32_16x16x32_bf16 v[204:207], a[44:47], a[84:87], v[204:207]
ds_read_b64_tr_b16 a[16:17], v24 offset:0
v_mfma_f32_16x16x32_bf16 v[208:211], a[48:51], a[76:79], v[208:211]
ds_read_b64_tr_b16 a[18:19], v24 offset:1024
v_mfma_f32_16x16x32_bf16 v[212:215], a[48:51], a[80:83], v[212:215]
ds_read_b64_tr_b16 a[20:21], v25 offset:0
v_mfma_f32_16x16x32_bf16 v[216:219], a[48:51], a[84:87], v[216:219]
ds_read_b64_tr_b16 a[22:23], v25 offset:1024
buffer_load_dwordx4 v11, s[8:11], s30 offen offset:3072 lds
v_mfma_f32_16x16x32_bf16 v[220:223], a[52:55], a[76:79], v[220:223]
ds_read_b64_tr_b16 a[24:25], v26 offset:0
v_mfma_f32_16x16x32_bf16 v[224:227], a[52:55], a[80:83], v[224:227]
ds_read_b64_tr_b16 a[26:27], v26 offset:1024
v_mfma_f32_16x16x32_bf16 v[228:231], a[52:55], a[84:87], v[228:231]
ds_read_b64_tr_b16 a[28:29], v27 offset:0
s_add_u32 m0, s33, 0
v_mfma_f32_16x16x32_bf16 v[232:235], a[56:59], a[76:79], v[232:235]
ds_read_b64_tr_b16 a[30:31], v27 offset:1024
buffer_load_dwordx4 v12, s[4:7], s31 offen offset:0 lds
v_mfma_f32_16x16x32_bf16 v[236:239], a[56:59], a[80:83], v[236:239]
v_mfma_f32_16x16x32_bf16 v[240:243], a[56:59], a[84:87], v[240:243]
v_mfma_f32_16x16x32_bf16 v[244:247], a[60:63], a[76:79], v[244:247]
v_mfma_f32_16x16x32_bf16 v[248:251], a[60:63], a[80:83], v[248:251]
v_mfma_f32_16x16x32_bf16 v[252:255], a[60:63], a[84:87], v[252:255]
s_waitcnt lgkmcnt(0)
v_mfma_f32_16x16x32_bf16 v[160:163], a[0:3], a[64:67], v[160:163]
ds_read_b128 a[76:79], v29 offset:6144
v_mfma_f32_16x16x32_bf16 v[164:167], a[0:3], a[68:71], v[164:167]
ds_read_b128 a[80:83], v29 offset:8192
buffer_load_dwordx4 v13, s[4:7], s31 offen offset:1024 lds
v_mfma_f32_16x16x32_bf16 v[168:171], a[0:3], a[72:75], v[168:171]
ds_read_b128 a[84:87], v29 offset:10240
s_add_u32 s55, s0, 15
v_mfma_f32_16x16x32_bf16 v[172:175], a[4:7], a[64:67], v[172:175]
ds_read_b64_tr_b16 a[32:33], v20 offset:8192
v_mfma_f32_16x16x32_bf16 v[176:179], a[4:7], a[68:71], v[176:179]
ds_read_b64_tr_b16 a[34:35], v20 offset:9216
s_and_b32 s55, s55, 15
v_mfma_f32_16x16x32_bf16 v[180:183], a[4:7], a[72:75], v[180:183]
ds_read_b64_tr_b16 a[36:37], v21 offset:8192
buffer_load_dwordx4 v14, s[4:7], s31 offen offset:2048 lds
v_mfma_f32_16x16x32_bf16 v[184:187], a[8:11], a[64:67], v[184:187]
ds_read_b64_tr_b16 a[38:39], v21 offset:9216
s_add_u32 s53, s55, s1
v_mfma_f32_16x16x32_bf16 v[188:191], a[8:11], a[68:71], v[188:191]
ds_read_b64_tr_b16 a[40:41], v22 offset:8192
v_mfma_f32_16x16x32_bf16 v[192:195], a[8:11], a[72:75], v[192:195]
ds_read_b64_tr_b16 a[42:43], v22 offset:9216
s_and_b32 s53, s53, 3
v_mfma_f32_16x16x32_bf16 v[196:199], a[12:15], a[64:67], v[196:199]
ds_read_b64_tr_b16 a[44:45], v23 offset:8192
buffer_load_dwordx4 v15, s[4:7], s31 offen offset:3072 lds
v_mfma_f32_16x16x32_bf16 v[200:203], a[12:15], a[68:71], v[200:203]
ds_read_b64_tr_b16 a[46:47], v23 offset:9216
s_and_b32 s55, s55, 12
v_mfma_f32_16x16x32_bf16 v[204:207], a[12:15], a[72:75], v[204:207]
ds_read_b64_tr_b16 a[48:49], v24 offset:8192
v_mfma_f32_16x16x32_bf16 v[208:211], a[16:19], a[64:67], v[208:211]
ds_read_b64_tr_b16 a[50:51], v24 offset:9216
s_or_b32 s55, s55, s53
v_mfma_f32_16x16x32_bf16 v[212:215], a[16:19], a[68:71], v[212:215]
ds_read_b64_tr_b16 a[52:53], v25 offset:8192
s_add_u32 m0, s33, 4096
v_mfma_f32_16x16x32_bf16 v[216:219], a[16:19], a[72:75], v[216:219]
ds_read_b64_tr_b16 a[54:55], v25 offset:9216
buffer_load_dwordx4 v16, s[4:7], s31 offen offset:0 lds
s_lshl_b32 s52, s55, 19
v_mfma_f32_16x16x32_bf16 v[220:223], a[20:23], a[64:67], v[220:223]
ds_read_b64_tr_b16 a[56:57], v26 offset:8192
v_mfma_f32_16x16x32_bf16 v[224:227], a[20:23], a[68:71], v[224:227]
ds_read_b64_tr_b16 a[58:59], v26 offset:9216
s_lshl_b32 s53, s55, 7
v_mfma_f32_16x16x32_bf16 v[228:231], a[20:23], a[72:75], v[228:231]
ds_read_b64_tr_b16 a[60:61], v27 offset:8192
v_mfma_f32_16x16x32_bf16 v[232:235], a[24:27], a[64:67], v[232:235]
ds_read_b64_tr_b16 a[62:63], v27 offset:9216
buffer_load_dwordx4 v17, s[4:7], s31 offen offset:1024 lds
v_mfma_f32_16x16x32_bf16 v[236:239], a[24:27], a[68:71], v[236:239]
v_mfma_f32_16x16x32_bf16 v[240:243], a[24:27], a[72:75], v[240:243]
v_mfma_f32_16x16x32_bf16 v[244:247], a[28:31], a[64:67], v[244:247]
v_mfma_f32_16x16x32_bf16 v[248:251], a[28:31], a[68:71], v[248:251]
v_mfma_f32_16x16x32_bf16 v[252:255], a[28:31], a[72:75], v[252:255]
s_waitcnt vmcnt(10) lgkmcnt(0)
s_barrier
v_mfma_f32_16x16x32_bf16 v[160:163], a[32:35], a[76:79], v[160:163]
ds_read_b128 a[64:67], v28 offset:12288
s_add_u32 m0, s32, 0
v_mfma_f32_16x16x32_bf16 v[164:167], a[32:35], a[80:83], v[164:167]
ds_read_b128 a[68:71], v28 offset:14336
buffer_load_dwordx4 v8, s[8:11], s52 offen offset:0 lds
v_mfma_f32_16x16x32_bf16 v[168:171], a[32:35], a[84:87], v[168:171]
ds_read_b128 a[72:75], v28 offset:16384
v_mfma_f32_16x16x32_bf16 v[172:175], a[36:39], a[76:79], v[172:175]
ds_read_b64_tr_b16 a[0:1], v20 offset:16384
v_mfma_f32_16x16x32_bf16 v[176:179], a[36:39], a[80:83], v[176:179]
ds_read_b64_tr_b16 a[2:3], v20 offset:17408
buffer_load_dwordx4 v9, s[8:11], s52 offen offset:1024 lds
v_mfma_f32_16x16x32_bf16 v[180:183], a[36:39], a[84:87], v[180:183]
ds_read_b64_tr_b16 a[4:5], v21 offset:16384
v_mfma_f32_16x16x32_bf16 v[184:187], a[40:43], a[76:79], v[184:187]
ds_read_b64_tr_b16 a[6:7], v21 offset:17408
v_mfma_f32_16x16x32_bf16 v[188:191], a[40:43], a[80:83], v[188:191]
ds_read_b64_tr_b16 a[8:9], v22 offset:16384
buffer_load_dwordx4 v10, s[8:11], s52 offen offset:2048 lds
v_mfma_f32_16x16x32_bf16 v[192:195], a[40:43], a[84:87], v[192:195]
ds_read_b64_tr_b16 a[10:11], v22 offset:17408
v_mfma_f32_16x16x32_bf16 v[196:199], a[44:47], a[76:79], v[196:199]
ds_read_b64_tr_b16 a[12:13], v23 offset:16384
v_mfma_f32_16x16x32_bf16 v[200:203], a[44:47], a[80:83], v[200:203]
ds_read_b64_tr_b16 a[14:15], v23 offset:17408
buffer_load_dwordx4 v11, s[8:11], s52 offen offset:3072 lds
v_mfma_f32_16x16x32_bf16 v[204:207], a[44:47], a[84:87], v[204:207]
ds_read_b64_tr_b16 a[16:17], v24 offset:16384
v_mfma_f32_16x16x32_bf16 v[208:211], a[48:51], a[76:79], v[208:211]
ds_read_b64_tr_b16 a[18:19], v24 offset:17408
s_add_u32 m0, s33, 16384
s_add_u32 s35, s38, 0
v_mfma_f32_16x16x32_bf16 v[212:215], a[48:51], a[80:83], v[212:215]
ds_read_b64_tr_b16 a[20:21], v25 offset:16384
buffer_load_dwordx4 v34, s[16:19], s35 offen offset:2048 nt lds
v_mfma_f32_16x16x32_bf16 v[216:219], a[48:51], a[84:87], v[216:219]
ds_read_b64_tr_b16 a[22:23], v25 offset:17408
v_mfma_f32_16x16x32_bf16 v[220:223], a[52:55], a[76:79], v[220:223]
ds_read_b64_tr_b16 a[24:25], v26 offset:16384
s_add_u32 s35, s38, 0
v_mfma_f32_16x16x32_bf16 v[224:227], a[52:55], a[80:83], v[224:227]
ds_read_b64_tr_b16 a[26:27], v26 offset:17408
buffer_load_dwordx4 v35, s[16:19], s35 offen offset:3072 nt lds
v_mfma_f32_16x16x32_bf16 v[228:231], a[52:55], a[84:87], v[228:231]
ds_read_b64_tr_b16 a[28:29], v27 offset:16384
v_mfma_f32_16x16x32_bf16 v[232:235], a[56:59], a[76:79], v[232:235]
ds_read_b64_tr_b16 a[30:31], v27 offset:17408
s_add_u32 m0, s33, 6144
v_mfma_f32_16x16x32_bf16 v[236:239], a[56:59], a[80:83], v[236:239]
buffer_load_dwordx4 v12, s[4:7], s53 offen offset:0 lds
v_mfma_f32_16x16x32_bf16 v[240:243], a[56:59], a[84:87], v[240:243]
v_mfma_f32_16x16x32_bf16 v[244:247], a[60:63], a[76:79], v[244:247]
v_mfma_f32_16x16x32_bf16 v[248:251], a[60:63], a[80:83], v[248:251]
v_mfma_f32_16x16x32_bf16 v[252:255], a[60:63], a[84:87], v[252:255]
s_waitcnt lgkmcnt(0)
v_mfma_f32_16x16x32_bf16 v[160:163], a[0:3], a[64:67], v[160:163]
ds_read_b128 a[76:79], v29 offset:12288
v_mfma_f32_16x16x32_bf16 v[164:167], a[0:3], a[68:71], v[164:167]
ds_read_b128 a[80:83], v29 offset:14336
buffer_load_dwordx4 v13, s[4:7], s53 offen offset:1024 lds
v_mfma_f32_16x16x32_bf16 v[168:171], a[0:3], a[72:75], v[168:171]
ds_read_b128 a[84:87], v29 offset:16384
v_mfma_f32_16x16x32_bf16 v[172:175], a[4:7], a[64:67], v[172:175]
ds_read_b64_tr_b16 a[32:33], v20 offset:24576
v_mfma_f32_16x16x32_bf16 v[176:179], a[4:7], a[68:71], v[176:179]
ds_read_b64_tr_b16 a[34:35], v20 offset:25600
buffer_load_dwordx4 v14, s[4:7], s53 offen offset:2048 lds
v_mfma_f32_16x16x32_bf16 v[180:183], a[4:7], a[72:75], v[180:183]
ds_read_b64_tr_b16 a[36:37], v21 offset:24576
v_mfma_f32_16x16x32_bf16 v[184:187], a[8:11], a[64:67], v[184:187]
ds_read_b64_tr_b16 a[38:39], v21 offset:25600
v_mfma_f32_16x16x32_bf16 v[188:191], a[8:11], a[68:71], v[188:191]
ds_read_b64_tr_b16 a[40:41], v22 offset:24576
buffer_load_dwordx4 v15, s[4:7], s53 offen offset:3072 lds
v_mfma_f32_16x16x32_bf16 v[192:195], a[8:11], a[72:75], v[192:195]
ds_read_b64_tr_b16 a[42:43], v22 offset:25600
v_mfma_f32_16x16x32_bf16 v[196:199], a[12:15], a[64:67], v[196:199]
ds_read_b64_tr_b16 a[44:45], v23 offset:24576
s_add_u32 m0, s33, 10240
v_mfma_f32_16x16x32_bf16 v[200:203], a[12:15], a[68:71], v[200:203]
ds_read_b64_tr_b16 a[46:47], v23 offset:25600
buffer_load_dwordx4 v16, s[4:7], s53 offen offset:0 lds
v_mfma_f32_16x16x32_bf16 v[204:207], a[12:15], a[72:75], v[204:207]
ds_read_b64_tr_b16 a[48:49], v24 offset:24576
v_mfma_f32_16x16x32_bf16 v[208:211], a[16:19], a[64:67], v[208:211]
ds_read_b64_tr_b16 a[50:51], v24 offset:25600
v_mfma_f32_16x16x32_bf16 v[212:215], a[16:19], a[68:71], v[212:215]
ds_read_b64_tr_b16 a[52:53], v25 offset:24576
buffer_load_dwordx4 v17, s[4:7], s53 offen offset:1024 lds
v_mfma_f32_16x16x32_bf16 v[216:219], a[16:19], a[72:75], v[216:219]
ds_read_b64_tr_b16 a[54:55], v25 offset:25600
v_mfma_f32_16x16x32_bf16 v[220:223], a[20:23], a[64:67], v[220:223]
ds_read_b64_tr_b16 a[56:57], v26 offset:24576
s_add_u32 m0, s33, 20480
s_add_u32 s35, s38, 4096
v_mfma_f32_16x16x32_bf16 v[224:227], a[20:23], a[68:71], v[224:227]
ds_read_b64_tr_b16 a[58:59], v26 offset:25600
buffer_load_dwordx4 v34, s[16:19], s35 offen offset:0 nt lds
v_mfma_f32_16x16x32_bf16 v[228:231], a[20:23], a[72:75], v[228:231]
ds_read_b64_tr_b16 a[60:61], v27 offset:24576
v_mfma_f32_16x16x32_bf16 v[232:235], a[24:27], a[64:67], v[232:235]
ds_read_b64_tr_b16 a[62:63], v27 offset:25600
s_add_u32 s35, s38, 4096
v_mfma_f32_16x16x32_bf16 v[236:239], a[24:27], a[68:71], v[236:239]
buffer_load_dwordx4 v35, s[16:19], s35 offen offset:1024 nt lds
v_mfma_f32_16x16x32_bf16 v[240:243], a[24:27], a[72:75], v[240:243]
v_mfma_f32_16x16x32_bf16 v[244:247], a[28:31], a[64:67], v[244:247]
v_mfma_f32_16x16x32_bf16 v[248:251], a[28:31], a[68:71], v[248:251]
v_mfma_f32_16x16x32_bf16 v[252:255], a[28:31], a[72:75], v[252:255]
s_waitcnt vmcnt(14) lgkmcnt(0)
s_barrier
v_mfma_f32_16x16x32_bf16 v[160:163], a[32:35], a[76:79], v[160:163]
ds_read_b128 a[64:67], v28 offset:0
s_add_u32 s35, s38, 4096
v_mfma_f32_16x16x32_bf16 v[164:167], a[32:35], a[80:83], v[164:167]
ds_read_b128 a[68:71], v28 offset:2048
buffer_load_dwordx4 v34, s[16:19], s35 offen offset:2048 nt lds
v_mfma_f32_16x16x32_bf16 v[168:171], a[32:35], a[84:87], v[168:171]
ds_read_b128 a[72:75], v28 offset:4096
v_mfma_f32_16x16x32_bf16 v[172:175], a[36:39], a[76:79], v[172:175]
ds_read_b64_tr_b16 a[0:1], v20 offset:32768
v_mfma_f32_16x16x32_bf16 v[176:179], a[36:39], a[80:83], v[176:179]
ds_read_b64_tr_b16 a[2:3], v20 offset:33792
v_mfma_f32_16x16x32_bf16 v[180:183], a[36:39], a[84:87], v[180:183]
ds_read_b64_tr_b16 a[4:5], v21 offset:32768
v_mfma_f32_16x16x32_bf16 v[184:187], a[40:43], a[76:79], v[184:187]
ds_read_b64_tr_b16 a[6:7], v21 offset:33792
v_mfma_f32_16x16x32_bf16 v[188:191], a[40:43], a[80:83], v[188:191]
ds_read_b64_tr_b16 a[8:9], v22 offset:32768
s_add_u32 s35, s38, 4096
v_mfma_f32_16x16x32_bf16 v[192:195], a[40:43], a[84:87], v[192:195]
ds_read_b64_tr_b16 a[10:11], v22 offset:33792
buffer_load_dwordx4 v35, s[16:19], s35 offen offset:3072 nt lds
v_mfma_f32_16x16x32_bf16 v[196:199], a[44:47], a[76:79], v[196:199]
ds_read_b64_tr_b16 a[12:13], v23 offset:32768
v_mfma_f32_16x16x32_bf16 v[200:203], a[44:47], a[80:83], v[200:203]
ds_read_b64_tr_b16 a[14:15], v23 offset:33792
v_mfma_f32_16x16x32_bf16 v[204:207], a[44:47], a[84:87], v[204:207]
ds_read_b64_tr_b16 a[16:17], v24 offset:32768
v_mfma_f32_16x16x32_bf16 v[208:211], a[48:51], a[76:79], v[208:211]
ds_read_b64_tr_b16 a[18:19], v24 offset:33792
v_mfma_f32_16x16x32_bf16 v[212:215], a[48:51], a[80:83], v[212:215]
ds_read_b64_tr_b16 a[20:21], v25 offset:32768
v_mfma_f32_16x16x32_bf16 v[216:219], a[48:51], a[84:87], v[216:219]
ds_read_b64_tr_b16 a[22:23], v25 offset:33792
s_add_u32 m0, s33, 16384
s_add_u32 s35, s38, 0
v_mfma_f32_16x16x32_bf16 v[220:223], a[52:55], a[76:79], v[220:223]
ds_read_b64_tr_b16 a[24:25], v26 offset:32768
buffer_load_dwordx4 v34, s[16:19], s35 offen offset:0 nt lds
v_mfma_f32_16x16x32_bf16 v[224:227], a[52:55], a[80:83], v[224:227]
ds_read_b64_tr_b16 a[26:27], v26 offset:33792
v_mfma_f32_16x16x32_bf16 v[228:231], a[52:55], a[84:87], v[228:231]
ds_read_b64_tr_b16 a[28:29], v27 offset:32768
v_mfma_f32_16x16x32_bf16 v[232:235], a[56:59], a[76:79], v[232:235]
ds_read_b64_tr_b16 a[30:31], v27 offset:33792
v_mfma_f32_16x16x32_bf16 v[236:239], a[56:59], a[80:83], v[236:239]
v_mfma_f32_16x16x32_bf16 v[240:243], a[56:59], a[84:87], v[240:243]
v_mfma_f32_16x16x32_bf16 v[244:247], a[60:63], a[76:79], v[244:247]
v_mfma_f32_16x16x32_bf16 v[248:251], a[60:63], a[80:83], v[248:251]
v_mfma_f32_16x16x32_bf16 v[252:255], a[60:63], a[84:87], v[252:255]
s_waitcnt lgkmcnt(0)
v_mfma_f32_16x16x32_bf16 v[160:163], a[0:3], a[64:67], v[160:163]
ds_read_b128 a[76:79], v29 offset:0
s_add_u32 s35, s38, 0
v_mfma_f32_16x16x32_bf16 v[164:167], a[0:3], a[68:71], v[164:167]
ds_read_b128 a[80:83], v29 offset:2048
buffer_load_dwordx4 v35, s[16:19], s35 offen offset:1024 nt lds
v_mfma_f32_16x16x32_bf16 v[168:171], a[0:3], a[72:75], v[168:171]
ds_read_b128 a[84:87], v29 offset:4096
v_mfma_f32_16x16x32_bf16 v[172:175], a[4:7], a[64:67], v[172:175]
ds_read_b64_tr_b16 a[32:33], v20 offset:40960
v_mfma_f32_16x16x32_bf16 v[176:179], a[4:7], a[68:71], v[176:179]
ds_read_b64_tr_b16 a[34:35], v20 offset:41984
v_mfma_f32_16x16x32_bf16 v[180:183], a[4:7], a[72:75], v[180:183]
ds_read_b64_tr_b16 a[36:37], v21 offset:40960
v_mfma_f32_16x16x32_bf16 v[184:187], a[8:11], a[64:67], v[184:187]
ds_read_b64_tr_b16 a[38:39], v21 offset:41984
v_mfma_f32_16x16x32_bf16 v[188:191], a[8:11], a[68:71], v[188:191]
ds_read_b64_tr_b16 a[40:41], v22 offset:40960
s_add_u32 m0, s33, 24576
s_add_u32 s35, s38, 8192
v_mfma_f32_16x16x32_bf16 v[192:195], a[8:11], a[72:75], v[192:195]
ds_read_b64_tr_b16 a[42:43], v22 offset:41984
buffer_load_dwordx4 v34, s[16:19], s35 offen offset:0 nt lds
v_mfma_f32_16x16x32_bf16 v[196:199], a[12:15], a[64:67], v[196:199]
ds_read_b64_tr_b16 a[44:45], v23 offset:40960
v_mfma_f32_16x16x32_bf16 v[200:203], a[12:15], a[68:71], v[200:203]
ds_read_b64_tr_b16 a[46:47], v23 offset:41984
v_mfma_f32_16x16x32_bf16 v[204:207], a[12:15], a[72:75], v[204:207]
ds_read_b64_tr_b16 a[48:49], v24 offset:40960
v_mfma_f32_16x16x32_bf16 v[208:211], a[16:19], a[64:67], v[208:211]
ds_read_b64_tr_b16 a[50:51], v24 offset:41984
v_mfma_f32_16x16x32_bf16 v[212:215], a[16:19], a[68:71], v[212:215]
ds_read_b64_tr_b16 a[52:53], v25 offset:40960
v_mfma_f32_16x16x32_bf16 v[216:219], a[16:19], a[72:75], v[216:219]
ds_read_b64_tr_b16 a[54:55], v25 offset:41984
s_add_u32 s35, s38, 8192
v_mfma_f32_16x16x32_bf16 v[220:223], a[20:23], a[64:67], v[220:223]
ds_read_b64_tr_b16 a[56:57], v26 offset:40960
buffer_load_dwordx4 v35, s[16:19], s35 offen offset:1024 nt lds
v_mfma_f32_16x16x32_bf16 v[224:227], a[20:23], a[68:71], v[224:227]
ds_read_b64_tr_b16 a[58:59], v26 offset:41984
v_mfma_f32_16x16x32_bf16 v[228:231], a[20:23], a[72:75], v[228:231]
ds_read_b64_tr_b16 a[60:61], v27 offset:40960
v_mfma_f32_16x16x32_bf16 v[232:235], a[24:27], a[64:67], v[232:235]
ds_read_b64_tr_b16 a[62:63], v27 offset:41984
v_mfma_f32_16x16x32_bf16 v[236:239], a[24:27], a[68:71], v[236:239]
v_mfma_f32_16x16x32_bf16 v[240:243], a[24:27], a[72:75], v[240:243]
v_mfma_f32_16x16x32_bf16 v[244:247], a[28:31], a[64:67], v[244:247]
v_mfma_f32_16x16x32_bf16 v[248:251], a[28:31], a[68:71], v[248:251]
v_mfma_f32_16x16x32_bf16 v[252:255], a[28:31], a[72:75], v[252:255]
s_waitcnt vmcnt(8) lgkmcnt(0)
s_barrier
v_mfma_f32_16x16x32_bf16 v[160:163], a[32:35], a[76:79], v[160:163]
ds_read_b128 a[64:67], v28 offset:6144
s_add_u32 s35, s38, 8192
v_mfma_f32_16x16x32_bf16 v[164:167], a[32:35], a[80:83], v[164:167]
ds_read_b128 a[68:71], v28 offset:8192
buffer_load_dwordx4 v34, s[16:19], s35 offen offset:2048 nt lds
v_mfma_f32_16x16x32_bf16 v[168:171], a[32:35], a[84:87], v[168:171]
ds_read_b128 a[72:75], v28 offset:10240
v_mfma_f32_16x16x32_bf16 v[172:175], a[36:39], a[76:79], v[172:175]
ds_read_b64_tr_b16 a[0:1], v20 offset:0
v_mfma_f32_16x16x32_bf16 v[176:179], a[36:39], a[80:83], v[176:179]
ds_read_b64_tr_b16 a[2:3], v20 offset:1024
v_mfma_f32_16x16x32_bf16 v[180:183], a[36:39], a[84:87], v[180:183]
ds_read_b64_tr_b16 a[4:5], v21 offset:0
v_mfma_f32_16x16x32_bf16 v[184:187], a[40:43], a[76:79], v[184:187]
ds_read_b64_tr_b16 a[6:7], v21 offset:1024
v_mfma_f32_16x16x32_bf16 v[188:191], a[40:43], a[80:83], v[188:191]
ds_read_b64_tr_b16 a[8:9], v22 offset:0
v_mfma_f32_16x16x32_bf16 v[192:195], a[40:43], a[84:87], v[192:195]
ds_read_b64_tr_b16 a[10:11], v22 offset:1024
v_mfma_f32_16x16x32_bf16 v[196:199], a[44:47], a[76:79], v[196:199]
ds_read_b64_tr_b16 a[12:13], v23 offset:0
v_mfma_f32_16x16x32_bf16 v[200:203], a[44:47], a[80:83], v[200:203]
ds_read_b64_tr_b16 a[14:15], v23 offset:1024
v_mfma_f32_16x16x32_bf16 v[204:207], a[44:47], a[84:87], v[204:207]
ds_read_b64_tr_b16 a[16:17], v24 offset:0
s_add_u32 s35, s38, 8192
v_mfma_f32_16x16x32_bf16 v[208:211], a[48:51], a[76:79], v[208:211]
ds_read_b64_tr_b16 a[18:19], v24 offset:1024
buffer_load_dwordx4 v35, s[16:19], s35 offen offset:3072 nt lds
v_mfma_f32_16x16x32_bf16 v[212:215], a[48:51], a[80:83], v[212:215]
ds_read_b64_tr_b16 a[20:21], v25 offset:0
v_mfma_f32_16x16x32_bf16 v[216:219], a[48:51], a[84:87], v[216:219]
ds_read_b64_tr_b16 a[22:23], v25 offset:1024
v_mfma_f32_16x16x32_bf16 v[220:223], a[52:55], a[76:79], v[220:223]
ds_read_b64_tr_b16 a[24:25], v26 offset:0
v_mfma_f32_16x16x32_bf16 v[224:227], a[52:55], a[80:83], v[224:227]
ds_read_b64_tr_b16 a[26:27], v26 offset:1024
v_mfma_f32_16x16x32_bf16 v[228:231], a[52:55], a[84:87], v[228:231]
ds_read_b64_tr_b16 a[28:29], v27 offset:0
v_mfma_f32_16x16x32_bf16 v[232:235], a[56:59], a[76:79], v[232:235]
ds_read_b64_tr_b16 a[30:31], v27 offset:1024
v_mfma_f32_16x16x32_bf16 v[236:239], a[56:59], a[80:83], v[236:239]
v_mfma_f32_16x16x32_bf16 v[240:243], a[56:59], a[84:87], v[240:243]
v_mfma_f32_16x16x32_bf16 v[244:247], a[60:63], a[76:79], v[244:247]
v_mfma_f32_16x16x32_bf16 v[248:251], a[60:63], a[80:83], v[248:251]
v_mfma_f32_16x16x32_bf16 v[252:255], a[60:63], a[84:87], v[252:255]
s_waitcnt lgkmcnt(0)
v_mfma_f32_16x16x32_bf16 v[160:163], a[0:3], a[64:67], v[160:163]
ds_read_b128 a[76:79], v29 offset:6144
v_mfma_f32_16x16x32_bf16 v[164:167], a[0:3], a[68:71], v[164:167]
ds_read_b128 a[80:83], v29 offset:8192
v_mfma_f32_16x16x32_bf16 v[168:171], a[0:3], a[72:75], v[168:171]
ds_read_b128 a[84:87], v29 offset:10240
v_mfma_f32_16x16x32_bf16 v[172:175], a[4:7], a[64:67], v[172:175]
ds_read_b64_tr_b16 a[32:33], v20 offset:8192
v_mfma_f32_16x16x32_bf16 v[176:179], a[4:7], a[68:71], v[176:179]
ds_read_b64_tr_b16 a[34:35], v20 offset:9216
v_mfma_f32_16x16x32_bf16 v[180:183], a[4:7], a[72:75], v[180:183]
ds_read_b64_tr_b16 a[36:37], v21 offset:8192
v_mfma_f32_16x16x32_bf16 v[184:187], a[8:11], a[64:67], v[184:187]
ds_read_b64_tr_b16 a[38:39], v21 offset:9216
v_mfma_f32_16x16x32_bf16 v[188:191], a[8:11], a[68:71], v[188:191]
ds_read_b64_tr_b16 a[40:41], v22 offset:8192
v_mfma_f32_16x16x32_bf16 v[192:195], a[8:11], a[72:75], v[192:195]
ds_read_b64_tr_b16 a[42:43], v22 offset:9216
v_mfma_f32_16x16x32_bf16 v[196:199], a[12:15], a[64:67], v[196:199]
ds_read_b64_tr_b16 a[44:45], v23 offset:8192
v_mfma_f32_16x16x32_bf16 v[200:203], a[12:15], a[68:71], v[200:203]
ds_read_b64_tr_b16 a[46:47], v23 offset:9216
v_mfma_f32_16x16x32_bf16 v[204:207], a[12:15], a[72:75], v[204:207]
ds_read_b64_tr_b16 a[48:49], v24 offset:8192
v_mfma_f32_16x16x32_bf16 v[208:211], a[16:19], a[64:67], v[208:211]
ds_read_b64_tr_b16 a[50:51], v24 offset:9216
v_mfma_f32_16x16x32_bf16 v[212:215], a[16:19], a[68:71], v[212:215]
ds_read_b64_tr_b16 a[52:53], v25 offset:8192
v_mfma_f32_16x16x32_bf16 v[216:219], a[16:19], a[72:75], v[216:219]
ds_read_b64_tr_b16 a[54:55], v25 offset:9216
v_mfma_f32_16x16x32_bf16 v[220:223], a[20:23], a[64:67], v[220:223]
ds_read_b64_tr_b16 a[56:57], v26 offset:8192
v_mfma_f32_16x16x32_bf16 v[224:227], a[20:23], a[68:71], v[224:227]
ds_read_b64_tr_b16 a[58:59], v26 offset:9216
v_mfma_f32_16x16x32_bf16 v[228:231], a[20:23], a[72:75], v[228:231]
ds_read_b64_tr_b16 a[60:61], v27 offset:8192
v_mfma_f32_16x16x32_bf16 v[232:235], a[24:27], a[64:67], v[232:235]
ds_read_b64_tr_b16 a[62:63], v27 offset:9216
v_mfma_f32_16x16x32_bf16 v[236:239], a[24:27], a[68:71], v[236:239]
v_mfma_f32_16x16x32_bf16 v[240:243], a[24:27], a[72:75], v[240:243]
v_mfma_f32_16x16x32_bf16 v[244:247], a[28:31], a[64:67], v[244:247]
v_mfma_f32_16x16x32_bf16 v[248:251], a[28:31], a[68:71], v[248:251]
v_mfma_f32_16x16x32_bf16 v[252:255], a[28:31], a[72:75], v[252:255]
s_waitcnt lgkmcnt(0)
s_barrier
v_mfma_f32_16x16x32_bf16 v[160:163], a[32:35], a[76:79], v[160:163]
v_mfma_f32_16x16x32_bf16 v[164:167], a[32:35], a[80:83], v[164:167]
v_mfma_f32_16x16x32_bf16 v[168:171], a[32:35], a[84:87], v[168:171]
v_mfma_f32_16x16x32_bf16 v[172:175], a[36:39], a[76:79], v[172:175]
v_mfma_f32_16x16x32_bf16 v[176:179], a[36:39], a[80:83], v[176:179]
v_mfma_f32_16x16x32_bf16 v[180:183], a[36:39], a[84:87], v[180:183]
v_mfma_f32_16x16x32_bf16 v[184:187], a[40:43], a[76:79], v[184:187]
v_mfma_f32_16x16x32_bf16 v[188:191], a[40:43], a[80:83], v[188:191]
v_mfma_f32_16x16x32_bf16 v[192:195], a[40:43], a[84:87], v[192:195]
v_mfma_f32_16x16x32_bf16 v[196:199], a[44:47], a[76:79], v[196:199]
v_mfma_f32_16x16x32_bf16 v[200:203], a[44:47], a[80:83], v[200:203]
v_mfma_f32_16x16x32_bf16 v[204:207], a[44:47], a[84:87], v[204:207]
v_mfma_f32_16x16x32_bf16 v[208:211], a[48:51], a[76:79], v[208:211]
v_mfma_f32_16x16x32_bf16 v[212:215], a[48:51], a[80:83], v[212:215]
v_mfma_f32_16x16x32_bf16 v[216:219], a[48:51], a[84:87], v[216:219]
v_mfma_f32_16x16x32_bf16 v[220:223], a[52:55], a[76:79], v[220:223]
v_mfma_f32_16x16x32_bf16 v[224:227], a[52:55], a[80:83], v[224:227]
v_mfma_f32_16x16x32_bf16 v[228:231], a[52:55], a[84:87], v[228:231]
v_mfma_f32_16x16x32_bf16 v[232:235], a[56:59], a[76:79], v[232:235]
v_mfma_f32_16x16x32_bf16 v[236:239], a[56:59], a[80:83], v[236:239]
v_mfma_f32_16x16x32_bf16 v[240:243], a[56:59], a[84:87], v[240:243]
v_mfma_f32_16x16x32_bf16 v[244:247], a[60:63], a[76:79], v[244:247]
v_mfma_f32_16x16x32_bf16 v[248:251], a[60:63], a[80:83], v[248:251]
v_mfma_f32_16x16x32_bf16 v[252:255], a[60:63], a[84:87], v[252:255]
v_mov_b32 v62, 0
buffer_load_dwordx2 v[60:61], v62, s[48:51], 0 offen sc0 sc1
s_mov_b32 s34, 0x3e0293ee
s_mov_b32 s35, s34
v_cvt_pk_bf16_f32 v100, v160, v161
v_cvt_pk_bf16_f32 v101, v162, v163
v_cvt_pk_bf16_f32 v102, v172, v173
v_cvt_pk_bf16_f32 v103, v174, v175
s_add_u32 s3, s27, 1
s_and_b32 s3, s3, 3
s_mul_i32 s3, s3, 12288
v_add_u32 v8, s3, v52
s_add_u32 s3, s27, 2
s_and_b32 s3, s3, 3
s_mul_i32 s3, s3, 12288
v_add_u32 v9, s3, v52
s_add_u32 s3, s27, 3
s_and_b32 s3, s3, 3
s_mul_i32 s3, s3, 12288
v_add_u32 v10, s3, v52
s_add_u32 s3, s27, 4
s_and_b32 s3, s3, 3
s_mul_i32 s3, s3, 12288
v_add_u32 v11, s3, v52
v_cvt_pk_bf16_f32 v104, v184, v185
v_cvt_pk_bf16_f32 v105, v186, v187
v_cvt_pk_bf16_f32 v106, v196, v197
v_cvt_pk_bf16_f32 v107, v198, v199
v_cvt_pk_bf16_f32 v108, v208, v209
v_cvt_pk_bf16_f32 v109, v210, v211
v_cvt_pk_bf16_f32 v110, v220, v221
s_add_u32 m0, s32, 16384
s_nop 0
buffer_load_dwordx4 v148, s[40:43], s78 offen offset:0 lds
v_cvt_pk_bf16_f32 v111, v222, v223
v_cvt_pk_bf16_f32 v112, v232, v233
v_cvt_pk_bf16_f32 v113, v234, v235
v_cvt_pk_bf16_f32 v114, v244, v245
v_cvt_pk_bf16_f32 v115, v246, v247
v_mfma_f32_16x16x32_bf16 v[64:67], a[96:99], v[100:103], 0
v_cvt_pk_bf16_f32 v116, v164, v165
v_cvt_pk_bf16_f32 v117, v166, v167
v_mfma_f32_16x16x32_bf16 v[68:71], a[112:115], v[100:103], 0
v_cvt_pk_bf16_f32 v118, v176, v177
v_cvt_pk_bf16_f32 v119, v178, v179
v_mfma_f32_16x16x32_bf16 v[72:75], a[128:131], v[100:103], 0
v_cvt_pk_bf16_f32 v120, v188, v189
v_cvt_pk_bf16_f32 v121, v190, v191
v_mfma_f32_16x16x32_bf16 v[64:67], a[100:103], v[104:107], v[64:67]
v_cvt_pk_bf16_f32 v122, v200, v201
v_cvt_pk_bf16_f32 v123, v202, v203
v_mfma_f32_16x16x32_bf16 v[68:71], a[116:119], v[104:107], v[68:71]
v_cvt_pk_bf16_f32 v124, v212, v213
v_cvt_pk_bf16_f32 v125, v214, v215
v_mfma_f32_16x16x32_bf16 v[72:75], a[132:135], v[104:107], v[72:75]
v_cvt_pk_bf16_f32 v126, v224, v225
v_cvt_pk_bf16_f32 v127, v226, v227
v_mfma_f32_16x16x32_bf16 v[64:67], a[104:107], v[108:111], v[64:67]
buffer_load_dwordx4 v149, s[40:43], s78 offen offset:1024 lds
v_cvt_pk_bf16_f32 v128, v236, v237
v_cvt_pk_bf16_f32 v129, v238, v239
v_mfma_f32_16x16x32_bf16 v[68:71], a[120:123], v[108:111], v[68:71]
v_cvt_pk_bf16_f32 v130, v248, v249
v_cvt_pk_bf16_f32 v131, v250, v251
v_mfma_f32_16x16x32_bf16 v[72:75], a[136:139], v[108:111], v[72:75]
v_mfma_f32_16x16x32_bf16 v[64:67], a[108:111], v[112:115], v[64:67]
v_mfma_f32_16x16x32_bf16 v[68:71], a[124:127], v[112:115], v[68:71]
v_mfma_f32_16x16x32_bf16 v[72:75], a[140:143], v[112:115], v[72:75]
v_mfma_f32_16x16x32_bf16 v[76:79], a[96:99], v[116:119], 0
s_nop 4
v_max3_f32 v56, v64, v65, v66
v_max3_f32 v57, v67, v68, v69
v_mfma_f32_16x16x32_bf16 v[80:83], a[112:115], v[116:119], 0
v_max3_f32 v56, v56, v70, v71
v_max3_f32 v57, v57, v72, v73
v_mfma_f32_16x16x32_bf16 v[84:87], a[128:131], v[116:119], 0
v_max3_f32 v56, v56, v74, v75
v_max_f32 v56, v56, v57
v_mfma_f32_16x16x32_bf16 v[76:79], a[100:103], v[120:123], v[76:79]
v_mov_b32 v57, v56
s_nop 1
v_permlane32_swap_b32 v56, v57
v_mfma_f32_16x16x32_bf16 v[80:83], a[116:119], v[120:123], v[80:83]
v_max_f32 v56, v56, v57
v_mov_b32 v57, v56
buffer_load_dwordx4 v150, s[40:43], s78 offen offset:2048 lds
v_mfma_f32_16x16x32_bf16 v[84:87], a[132:135], v[120:123], v[84:87]
v_permlane16_swap_b32 v56, v57
v_max_f32 v56, v56, v57
v_mfma_f32_16x16x32_bf16 v[76:79], a[104:107], v[124:127], v[76:79]
v_mul_f32 v56, s34, v56
v_pk_fma_f32 v[64:65], v[64:65], s[34:35], v[56:57] op_sel_hi:[1,1,0] neg_lo:[0,0,1] neg_hi:[0,0,1]
v_mfma_f32_16x16x32_bf16 v[80:83], a[120:123], v[124:127], v[80:83]
v_pk_fma_f32 v[66:67], v[66:67], s[34:35], v[56:57] op_sel_hi:[1,1,0] neg_lo:[0,0,1] neg_hi:[0,0,1]
v_pk_fma_f32 v[68:69], v[68:69], s[34:35], v[56:57] op_sel_hi:[1,1,0] neg_lo:[0,0,1] neg_hi:[0,0,1]
v_mfma_f32_16x16x32_bf16 v[84:87], a[136:139], v[124:127], v[84:87]
v_pk_fma_f32 v[70:71], v[70:71], s[34:35], v[56:57] op_sel_hi:[1,1,0] neg_lo:[0,0,1] neg_hi:[0,0,1]
v_pk_fma_f32 v[72:73], v[72:73], s[34:35], v[56:57] op_sel_hi:[1,1,0] neg_lo:[0,0,1] neg_hi:[0,0,1]
v_mfma_f32_16x16x32_bf16 v[76:79], a[108:111], v[128:131], v[76:79]
v_pk_fma_f32 v[74:75], v[74:75], s[34:35], v[56:57] op_sel_hi:[1,1,0] neg_lo:[0,0,1] neg_hi:[0,0,1]
v_exp_f32 v64, v64
v_mfma_f32_16x16x32_bf16 v[80:83], a[124:127], v[128:131], v[80:83]
v_exp_f32 v65, v65
v_exp_f32 v66, v66
v_mfma_f32_16x16x32_bf16 v[84:87], a[140:143], v[128:131], v[84:87]
v_exp_f32 v67, v67
v_exp_f32 v68, v68
v_exp_f32 v69, v69
v_exp_f32 v70, v70
v_exp_f32 v71, v71
buffer_load_dwordx4 v151, s[40:43], s78 offen offset:3072 lds
v_exp_f32 v72, v72
v_exp_f32 v73, v73
v_exp_f32 v74, v74
s_waitcnt vmcnt(5)
v_exp_f32 v75, v75
ds_read_b64_tr_b16 a[144:145], v44 offset:0
v_pk_add_f32 v[58:59], v[64:65], v[66:67]
ds_read_b64_tr_b16 a[146:147], v44 offset:4096
v_pk_add_f32 v[56:57], v[68:69], v[70:71]
ds_read_b64_tr_b16 a[148:149], v44 offset:8192
v_pk_add_f32 v[58:59], v[58:59], v[72:73]
ds_read_b64_tr_b16 a[150:151], v45 offset:0
v_pk_add_f32 v[56:57], v[56:57], v[74:75]
ds_read_b64_tr_b16 a[152:153], v45 offset:4096
v_pk_add_f32 v[58:59], v[58:59], v[56:57]
ds_read_b64_tr_b16 a[154:155], v45 offset:8192
v_add_f32 v57, v58, v59
ds_read_b64_tr_b16 a[156:157], v46 offset:0
v_mov_b32 v58, v57
ds_read_b64_tr_b16 a[158:159], v46 offset:4096
s_nop 0
v_permlane32_swap_b32 v57, v58
ds_read_b64_tr_b16 a[160:161], v46 offset:8192
s_add_u32 s30, s78, 131072
s_add_u32 m0, s32, 32768
s_nop 0
buffer_load_dwordx4 v148, s[40:43], s30 offen offset:0 lds
v_add_f32 v57, v57, v58
ds_read_b64_tr_b16 a[162:163], v47 offset:0
v_mov_b32 v58, v57
ds_read_b64_tr_b16 a[164:165], v47 offset:4096
s_nop 0
v_permlane16_swap_b32 v57, v58
ds_read_b64_tr_b16 a[166:167], v47 offset:8192
v_add_f32 v57, v57, v58
ds_read_b64_tr_b16 a[168:169], v48 offset:0
v_rcp_f32 v56, v57
ds_read_b64_tr_b16 a[170:171], v48 offset:4096
v_pk_mul_f32 v[64:65], v[64:65], v[56:57] op_sel_hi:[1,0]
ds_read_b64_tr_b16 a[172:173], v48 offset:8192
v_pk_mul_f32 v[66:67], v[66:67], v[56:57] op_sel_hi:[1,0]
ds_read_b64_tr_b16 a[174:175], v49 offset:0
v_pk_mul_f32 v[68:69], v[68:69], v[56:57] op_sel_hi:[1,0]
ds_read_b64_tr_b16 a[176:177], v49 offset:4096
v_pk_mul_f32 v[70:71], v[70:71], v[56:57] op_sel_hi:[1,0]
ds_read_b64_tr_b16 a[178:179], v49 offset:8192
v_pk_mul_f32 v[72:73], v[72:73], v[56:57] op_sel_hi:[1,0]
ds_read_b64_tr_b16 a[180:181], v50 offset:0
v_pk_mul_f32 v[74:75], v[74:75], v[56:57] op_sel_hi:[1,0]
ds_read_b64_tr_b16 a[182:183], v50 offset:4096
v_cvt_pk_bf16_f32 v100, v64, v65
ds_read_b64_tr_b16 a[184:185], v50 offset:8192
buffer_load_dwordx4 v149, s[40:43], s30 offen offset:1024 lds
v_cvt_pk_bf16_f32 v101, v66, v67
ds_read_b64_tr_b16 a[186:187], v51 offset:0
v_cvt_pk_bf16_f32 v102, v68, v69
ds_read_b64_tr_b16 a[188:189], v51 offset:4096
v_cvt_pk_bf16_f32 v103, v70, v71
ds_read_b64_tr_b16 a[190:191], v51 offset:8192
v_cvt_pk_bf16_f32 v104, v72, v73
v_cvt_pk_bf16_f32 v105, v74, v75
s_waitcnt lgkmcnt(0)
s_barrier
v_mfma_f32_16x16x32_bf16 v[160:163], a[144:147], v[100:103], 0
v_cvt_pk_bf16_f32 v132, v168, v169
v_cvt_pk_bf16_f32 v133, v170, v171
v_mfma_f32_16x16x32_bf16 v[172:175], a[150:153], v[100:103], 0
v_cvt_pk_bf16_f32 v134, v180, v181
v_cvt_pk_bf16_f32 v135, v182, v183
v_mfma_f32_16x16x32_bf16 v[184:187], a[156:159], v[100:103], 0
v_cvt_pk_bf16_f32 v136, v192, v193
v_cvt_pk_bf16_f32 v137, v194, v195
v_mfma_f32_16x16x32_bf16 v[196:199], a[162:165], v[100:103], 0
v_cvt_pk_bf16_f32 v138, v204, v205
v_cvt_pk_bf16_f32 v139, v206, v207
v_mfma_f32_16x16x32_bf16 v[208:211], a[168:171], v[100:103], 0
buffer_load_dwordx4 v150, s[40:43], s30 offen offset:2048 lds
v_cvt_pk_bf16_f32 v140, v216, v217
v_cvt_pk_bf16_f32 v141, v218, v219
v_mfma_f32_16x16x32_bf16 v[220:223], a[174:177], v[100:103], 0
v_cvt_pk_bf16_f32 v142, v228, v229
v_cvt_pk_bf16_f32 v143, v230, v231
v_mfma_f32_16x16x32_bf16 v[232:235], a[180:183], v[100:103], 0
v_cvt_pk_bf16_f32 v144, v240, v241
v_cvt_pk_bf16_f32 v145, v242, v243
v_mfma_f32_16x16x32_bf16 v[244:247], a[186:189], v[100:103], 0
v_cvt_pk_bf16_f32 v146, v252, v253
v_cvt_pk_bf16_f32 v147, v254, v255
v_mfma_f32_16x16x16_bf16 v[160:163], a[148:149], v[104:105], v[160:163]
v_mfma_f32_16x16x16_bf16 v[172:175], a[154:155], v[104:105], v[172:175]
v_mfma_f32_16x16x16_bf16 v[184:187], a[160:161], v[104:105], v[184:187]
v_mfma_f32_16x16x16_bf16 v[196:199], a[166:167], v[104:105], v[196:199]
v_mfma_f32_16x16x16_bf16 v[208:211], a[172:173], v[104:105], v[208:211]
v_mfma_f32_16x16x16_bf16 v[220:223], a[178:179], v[104:105], v[220:223]
v_mfma_f32_16x16x16_bf16 v[232:235], a[184:185], v[104:105], v[232:235]
v_mfma_f32_16x16x16_bf16 v[244:247], a[190:191], v[104:105], v[244:247]
v_mfma_f32_16x16x32_bf16 v[88:91], a[96:99], v[132:135], 0
v_cvt_pk_bf16_f32 v100, v160, v161
v_cvt_pk_bf16_f32 v101, v162, v163
v_mfma_f32_16x16x32_bf16 v[92:95], a[112:115], v[132:135], 0
v_cvt_pk_bf16_f32 v102, v172, v173
buffer_load_dwordx4 v151, s[40:43], s30 offen offset:3072 lds
v_cvt_pk_bf16_f32 v103, v174, v175
v_mfma_f32_16x16x32_bf16 v[96:99], a[128:131], v[132:135], 0
s_add_u32 s57, s39, 0
buffer_store_dwordx4 v[100:103], v52, s[20:23], s57 offen offset:0 sc1
ds_write_b128 v54, v[100:103] offset:0
v_mfma_f32_16x16x32_bf16 v[88:91], a[100:103], v[136:139], v[88:91]
v_cvt_pk_bf16_f32 v104, v184, v185
v_cvt_pk_bf16_f32 v105, v186, v187
v_mfma_f32_16x16x32_bf16 v[92:95], a[116:119], v[136:139], v[92:95]
v_cvt_pk_bf16_f32 v106, v196, v197
v_cvt_pk_bf16_f32 v107, v198, v199
v_mfma_f32_16x16x32_bf16 v[96:99], a[132:135], v[136:139], v[96:99]
s_add_u32 s57, s39, 0
buffer_store_dwordx4 v[104:107], v52, s[20:23], s57 offen offset:1024 sc1
ds_write_b128 v54, v[104:107] offset:1024
v_mfma_f32_16x16x32_bf16 v[88:91], a[104:107], v[140:143], v[88:91]
v_cvt_pk_bf16_f32 v108, v208, v209
v_cvt_pk_bf16_f32 v109, v210, v211
v_mfma_f32_16x16x32_bf16 v[92:95], a[120:123], v[140:143], v[92:95]
v_cvt_pk_bf16_f32 v110, v220, v221
v_cvt_pk_bf16_f32 v111, v222, v223
v_mfma_f32_16x16x32_bf16 v[96:99], a[136:139], v[140:143], v[96:99]
s_add_u32 s57, s39, 0
buffer_store_dwordx4 v[108:111], v52, s[20:23], s57 offen offset:2048 sc1
ds_write_b128 v54, v[108:111] offset:2048
v_mfma_f32_16x16x32_bf16 v[88:91], a[108:111], v[144:147], v[88:91]
v_cvt_pk_bf16_f32 v112, v232, v233
s_add_u32 m0, s32, 0
s_nop 0
buffer_load_dwordx4 v148, s[40:43], s79 offen offset:0 lds
v_cvt_pk_bf16_f32 v113, v234, v235
v_mfma_f32_16x16x32_bf16 v[92:95], a[124:127], v[144:147], v[92:95]
v_cvt_pk_bf16_f32 v114, v244, v245
v_cvt_pk_bf16_f32 v115, v246, v247
v_mfma_f32_16x16x32_bf16 v[96:99], a[140:143], v[144:147], v[96:99]
s_add_u32 s57, s39, 0
buffer_store_dwordx4 v[112:115], v52, s[20:23], s57 offen offset:3072 sc1
ds_write_b128 v54, v[112:115] offset:3072
v_max3_f32 v56, v76, v77, v78
v_max3_f32 v57, v79, v80, v81
v_max3_f32 v56, v56, v82, v83
v_max3_f32 v57, v57, v84, v85
v_max3_f32 v56, v56, v86, v87
v_max_f32 v56, v56, v57
v_mov_b32 v57, v56
s_nop 1
v_permlane32_swap_b32 v56, v57
v_max_f32 v56, v56, v57
v_mov_b32 v57, v56
s_nop 1
v_permlane16_swap_b32 v56, v57
v_max_f32 v56, v56, v57
v_mul_f32 v56, s34, v56
v_pk_fma_f32 v[76:77], v[76:77], s[34:35], v[56:57] op_sel_hi:[1,1,0] neg_lo:[0,0,1] neg_hi:[0,0,1]
v_pk_fma_f32 v[78:79], v[78:79], s[34:35], v[56:57] op_sel_hi:[1,1,0] neg_lo:[0,0,1] neg_hi:[0,0,1]
v_pk_fma_f32 v[80:81], v[80:81], s[34:35], v[56:57] op_sel_hi:[1,1,0] neg_lo:[0,0,1] neg_hi:[0,0,1]
buffer_load_dwordx4 v149, s[40:43], s79 offen offset:1024 lds
v_pk_fma_f32 v[82:83], v[82:83], s[34:35], v[56:57] op_sel_hi:[1,1,0] neg_lo:[0,0,1] neg_hi:[0,0,1]
v_pk_fma_f32 v[84:85], v[84:85], s[34:35], v[56:57] op_sel_hi:[1,1,0] neg_lo:[0,0,1] neg_hi:[0,0,1]
v_pk_fma_f32 v[86:87], v[86:87], s[34:35], v[56:57] op_sel_hi:[1,1,0] neg_lo:[0,0,1] neg_hi:[0,0,1]
v_exp_f32 v76, v76
v_exp_f32 v77, v77
v_exp_f32 v78, v78
v_exp_f32 v79, v79
v_exp_f32 v80, v80
v_exp_f32 v81, v81
v_exp_f32 v82, v82
v_exp_f32 v83, v83
v_exp_f32 v84, v84
v_exp_f32 v85, v85
v_exp_f32 v86, v86
v_exp_f32 v87, v87
v_pk_add_f32 v[58:59], v[76:77], v[78:79]
v_pk_add_f32 v[56:57], v[80:81], v[82:83]
v_pk_add_f32 v[58:59], v[58:59], v[84:85]
v_pk_add_f32 v[56:57], v[56:57], v[86:87]
v_pk_add_f32 v[58:59], v[58:59], v[56:57]
v_add_f32 v57, v58, v59
v_mov_b32 v58, v57
s_nop 1
v_permlane32_swap_b32 v57, v58
v_add_f32 v57, v57, v58
buffer_load_dwordx4 v150, s[40:43], s79 offen offset:2048 lds
v_mov_b32 v58, v57
s_nop 1
v_permlane16_swap_b32 v57, v58
v_add_f32 v57, v57, v58
v_rcp_f32 v56, v57
s_nop 0
v_pk_mul_f32 v[76:77], v[76:77], v[56:57] op_sel_hi:[1,0]
v_pk_mul_f32 v[78:79], v[78:79], v[56:57] op_sel_hi:[1,0]
v_pk_mul_f32 v[80:81], v[80:81], v[56:57] op_sel_hi:[1,0]
v_pk_mul_f32 v[82:83], v[82:83], v[56:57] op_sel_hi:[1,0]
v_pk_mul_f32 v[84:85], v[84:85], v[56:57] op_sel_hi:[1,0]
v_pk_mul_f32 v[86:87], v[86:87], v[56:57] op_sel_hi:[1,0]
v_cvt_pk_bf16_f32 v116, v76, v77
v_cvt_pk_bf16_f32 v117, v78, v79
v_cvt_pk_bf16_f32 v118, v80, v81
v_cvt_pk_bf16_f32 v119, v82, v83
v_cvt_pk_bf16_f32 v120, v84, v85
v_cvt_pk_bf16_f32 v121, v86, v87
v_mfma_f32_16x16x32_bf16 v[164:167], a[144:147], v[116:119], 0
v_max3_f32 v56, v88, v89, v90
v_max3_f32 v57, v91, v92, v93
v_mfma_f32_16x16x32_bf16 v[176:179], a[150:153], v[116:119], 0
v_max3_f32 v56, v56, v94, v95
v_max3_f32 v57, v57, v96, v97
v_mfma_f32_16x16x32_bf16 v[188:191], a[156:159], v[116:119], 0
buffer_load_dwordx4 v151, s[40:43], s79 offen offset:3072 lds
v_max3_f32 v56, v56, v98, v99
v_max_f32 v56, v56, v57
v_mfma_f32_16x16x32_bf16 v[200:203], a[162:165], v[116:119], 0
v_mov_b32 v57, v56
s_nop 1
v_permlane32_swap_b32 v56, v57
v_mfma_f32_16x16x32_bf16 v[212:215], a[168:171], v[116:119], 0
v_max_f32 v56, v56, v57
v_mov_b32 v57, v56
v_mfma_f32_16x16x32_bf16 v[224:227], a[174:177], v[116:119], 0
s_nop 0
v_permlane16_swap_b32 v56, v57
v_max_f32 v56, v56, v57
v_mfma_f32_16x16x32_bf16 v[236:239], a[180:183], v[116:119], 0
v_mul_f32 v56, s34, v56
v_pk_fma_f32 v[88:89], v[88:89], s[34:35], v[56:57] op_sel_hi:[1,1,0] neg_lo:[0,0,1] neg_hi:[0,0,1]
v_mfma_f32_16x16x32_bf16 v[248:251], a[186:189], v[116:119], 0
v_pk_fma_f32 v[90:91], v[90:91], s[34:35], v[56:57] op_sel_hi:[1,1,0] neg_lo:[0,0,1] neg_hi:[0,0,1]
v_pk_fma_f32 v[92:93], v[92:93], s[34:35], v[56:57] op_sel_hi:[1,1,0] neg_lo:[0,0,1] neg_hi:[0,0,1]
v_mfma_f32_16x16x16_bf16 v[164:167], a[148:149], v[120:121], v[164:167]
v_pk_fma_f32 v[94:95], v[94:95], s[34:35], v[56:57] op_sel_hi:[1,1,0] neg_lo:[0,0,1] neg_hi:[0,0,1]
v_pk_fma_f32 v[96:97], v[96:97], s[34:35], v[56:57] op_sel_hi:[1,1,0] neg_lo:[0,0,1] neg_hi:[0,0,1]
v_mfma_f32_16x16x16_bf16 v[176:179], a[154:155], v[120:121], v[176:179]
v_pk_fma_f32 v[98:99], v[98:99], s[34:35], v[56:57] op_sel_hi:[1,1,0] neg_lo:[0,0,1] neg_hi:[0,0,1]
v_exp_f32 v88, v88
v_mfma_f32_16x16x16_bf16 v[188:191], a[160:161], v[120:121], v[188:191]
s_add_u32 s30, s79, 131072
s_add_u32 m0, s32, 81920
s_nop 0
buffer_load_dwordx4 v148, s[40:43], s30 offen offset:0 lds
v_exp_f32 v89, v89
v_exp_f32 v90, v90
v_mfma_f32_16x16x16_bf16 v[200:203], a[166:167], v[120:121], v[200:203]
v_exp_f32 v91, v91
v_exp_f32 v92, v92
v_mfma_f32_16x16x16_bf16 v[212:215], a[172:173], v[120:121], v[212:215]
v_exp_f32 v93, v93
v_exp_f32 v94, v94
v_mfma_f32_16x16x16_bf16 v[224:227], a[178:179], v[120:121], v[224:227]
v_exp_f32 v95, v95
v_exp_f32 v96, v96
v_mfma_f32_16x16x16_bf16 v[236:239], a[184:185], v[120:121], v[236:239]
v_exp_f32 v97, v97
v_exp_f32 v98, v98
v_mfma_f32_16x16x16_bf16 v[248:251], a[190:191], v[120:121], v[248:251]
v_exp_f32 v99, v99
v_pk_add_f32 v[58:59], v[88:89], v[90:91]
v_cvt_pk_bf16_f32 v116, v164, v165
v_cvt_pk_bf16_f32 v117, v166, v167
v_cvt_pk_bf16_f32 v118, v176, v177
v_cvt_pk_bf16_f32 v119, v178, v179
s_add_u32 s57, s39, 4096
buffer_store_dwordx4 v[116:119], v52, s[20:23], s57 offen offset:0 sc1
ds_write_b128 v54, v[116:119] offset:4096
v_cvt_pk_bf16_f32 v120, v188, v189
buffer_load_dwordx4 v149, s[40:43], s30 offen offset:1024 lds
v_cvt_pk_bf16_f32 v121, v190, v191
v_cvt_pk_bf16_f32 v122, v200, v201
v_cvt_pk_bf16_f32 v123, v202, v203
s_add_u32 s57, s39, 4096
buffer_store_dwordx4 v[120:123], v52, s[20:23], s57 offen offset:1024 sc1
ds_write_b128 v54, v[120:123] offset:5120
v_cvt_pk_bf16_f32 v124, v212, v213
v_cvt_pk_bf16_f32 v125, v214, v215
v_cvt_pk_bf16_f32 v126, v224, v225
v_cvt_pk_bf16_f32 v127, v226, v227
s_add_u32 s57, s39, 4096
buffer_store_dwordx4 v[124:127], v52, s[20:23], s57 offen offset:2048 sc1
ds_write_b128 v54, v[124:127] offset:6144
v_cvt_pk_bf16_f32 v128, v236, v237
v_cvt_pk_bf16_f32 v129, v238, v239
v_cvt_pk_bf16_f32 v130, v248, v249
v_cvt_pk_bf16_f32 v131, v250, v251
s_add_u32 s57, s39, 4096
buffer_store_dwordx4 v[128:131], v52, s[20:23], s57 offen offset:3072 sc1
ds_write_b128 v54, v[128:131] offset:7168
v_pk_add_f32 v[56:57], v[92:93], v[94:95]
v_pk_add_f32 v[58:59], v[58:59], v[96:97]
v_pk_add_f32 v[56:57], v[56:57], v[98:99]
v_pk_add_f32 v[58:59], v[58:59], v[56:57]
v_add_f32 v57, v58, v59
v_mov_b32 v58, v57
s_nop 1
v_permlane32_swap_b32 v57, v58
buffer_load_dwordx4 v150, s[40:43], s30 offen offset:2048 lds
v_add_f32 v57, v57, v58
v_mov_b32 v58, v57
s_nop 1
v_permlane16_swap_b32 v57, v58
v_add_f32 v57, v57, v58
v_rcp_f32 v56, v57
s_nop 0
v_pk_mul_f32 v[88:89], v[88:89], v[56:57] op_sel_hi:[1,0]
v_pk_mul_f32 v[90:91], v[90:91], v[56:57] op_sel_hi:[1,0]
v_pk_mul_f32 v[92:93], v[92:93], v[56:57] op_sel_hi:[1,0]
v_pk_mul_f32 v[94:95], v[94:95], v[56:57] op_sel_hi:[1,0]
v_pk_mul_f32 v[96:97], v[96:97], v[56:57] op_sel_hi:[1,0]
v_pk_mul_f32 v[98:99], v[98:99], v[56:57] op_sel_hi:[1,0]
v_cvt_pk_bf16_f32 v132, v88, v89
v_cvt_pk_bf16_f32 v133, v90, v91
v_cvt_pk_bf16_f32 v134, v92, v93
v_cvt_pk_bf16_f32 v135, v94, v95
v_cvt_pk_bf16_f32 v136, v96, v97
v_cvt_pk_bf16_f32 v137, v98, v99
v_mfma_f32_16x16x32_bf16 v[168:171], a[144:147], v[132:135], 0
v_mfma_f32_16x16x32_bf16 v[180:183], a[150:153], v[132:135], 0
v_mfma_f32_16x16x32_bf16 v[192:195], a[156:159], v[132:135], 0
v_mfma_f32_16x16x32_bf16 v[204:207], a[162:165], v[132:135], 0
v_mfma_f32_16x16x32_bf16 v[216:219], a[168:171], v[132:135], 0
v_mfma_f32_16x16x32_bf16 v[228:231], a[174:177], v[132:135], 0
buffer_load_dwordx4 v151, s[40:43], s30 offen offset:3072 lds
v_mfma_f32_16x16x32_bf16 v[240:243], a[180:183], v[132:135], 0
v_mfma_f32_16x16x32_bf16 v[252:255], a[186:189], v[132:135], 0
v_mfma_f32_16x16x16_bf16 v[168:171], a[148:149], v[136:137], v[168:171]
v_mfma_f32_16x16x16_bf16 v[180:183], a[154:155], v[136:137], v[180:183]
v_mfma_f32_16x16x16_bf16 v[192:195], a[160:161], v[136:137], v[192:195]
v_mfma_f32_16x16x16_bf16 v[204:207], a[166:167], v[136:137], v[204:207]
v_mfma_f32_16x16x16_bf16 v[216:219], a[172:173], v[136:137], v[216:219]
v_mfma_f32_16x16x16_bf16 v[228:231], a[178:179], v[136:137], v[228:231]
v_mfma_f32_16x16x16_bf16 v[240:243], a[184:185], v[136:137], v[240:243]
v_mfma_f32_16x16x16_bf16 v[252:255], a[190:191], v[136:137], v[252:255]
s_nop 0
v_cvt_pk_bf16_f32 v132, v168, v169
v_cvt_pk_bf16_f32 v133, v170, v171
v_cvt_pk_bf16_f32 v134, v180, v181
v_cvt_pk_bf16_f32 v135, v182, v183
s_add_u32 s57, s39, 8192
buffer_store_dwordx4 v[132:135], v52, s[20:23], s57 offen offset:0 sc1
ds_write_b128 v54, v[132:135] offset:8192
v_cvt_pk_bf16_f32 v136, v192, v193
v_cvt_pk_bf16_f32 v137, v194, v195
v_cvt_pk_bf16_f32 v138, v204, v205
v_cvt_pk_bf16_f32 v139, v206, v207
s_add_u32 s57, s39, 8192
buffer_store_dwordx4 v[136:139], v52, s[20:23], s57 offen offset:1024 sc1
ds_write_b128 v54, v[136:139] offset:9216
v_cvt_pk_bf16_f32 v140, v216, v217
v_cvt_pk_bf16_f32 v141, v218, v219
v_cvt_pk_bf16_f32 v142, v228, v229
v_cvt_pk_bf16_f32 v143, v230, v231
s_add_u32 s57, s39, 8192
buffer_store_dwordx4 v[140:143], v52, s[20:23], s57 offen offset:2048 sc1
ds_write_b128 v54, v[140:143] offset:10240
v_cvt_pk_bf16_f32 v144, v240, v241
v_cvt_pk_bf16_f32 v145, v242, v243
v_cvt_pk_bf16_f32 v146, v252, v253
v_cvt_pk_bf16_f32 v147, v254, v255
s_add_u32 s57, s39, 8192
buffer_store_dwordx4 v[144:147], v52, s[20:23], s57 offen offset:3072 sc1
ds_write_b128 v54, v[144:147] offset:11264
s_waitcnt vmcnt(28)
s_mov_b32 s59, 65536
L_nonce:
v_readfirstlane_b32 s52, v60
v_readfirstlane_b32 s53, v61
s_nop 2
s_cmp_lg_u32 s52, 0
s_cbranch_scc1 L_nonce_ok
s_sub_u32 s59, s59, 1
s_cmp_eq_u32 s59, 0
s_cbranch_scc1 L_nonce_ok
buffer_load_dwordx2 v[60:61], v62, s[48:51], 0 offen sc0 sc1
s_waitcnt vmcnt(0)
s_branch L_nonce
L_nonce_ok:
v_mov_b32 v60, s52
v_mov_b32 v61, s53
s_mov_b32 s54, 0
s_waitcnt lgkmcnt(0)
s_waitcnt vmcnt(20)
s_barrier
ds_read_b64_tr_b16 a[192:193], v18 offset:16384
ds_read_b64_tr_b16 a[194:195], v18 offset:20480
ds_read_b64_tr_b16 a[196:197], v19 offset:16384
ds_read_b64_tr_b16 a[198:199], v19 offset:20480
ds_read_b64_tr_b16 a[200:201], v18 offset:24576
ds_read_b64_tr_b16 a[202:203], v18 offset:28672
ds_read_b64_tr_b16 a[204:205], v19 offset:24576
ds_read_b64_tr_b16 a[206:207], v19 offset:28672
ds_read_b64_tr_b16 a[208:209], v18 offset:32768
ds_read_b64_tr_b16 a[210:211], v18 offset:36864
ds_read_b64_tr_b16 a[212:213], v19 offset:32768
ds_read_b64_tr_b16 a[214:215], v19 offset:36864
ds_read_b64_tr_b16 a[216:217], v18 offset:40960
ds_read_b64_tr_b16 a[218:219], v18 offset:45056
ds_read_b64_tr_b16 a[220:221], v19 offset:40960
ds_read_b64_tr_b16 a[222:223], v19 offset:45056
ds_read_b128 v[64:67], v55 offset:0
ds_read_b128 v[68:71], v55 offset:1024
ds_read_b128 v[72:75], v55 offset:2048
ds_read_b128 v[76:79], v55 offset:3072
ds_read_b128 v[80:83], v55 offset:4096
ds_read_b128 v[84:87], v55 offset:5120
ds_read_b128 v[88:91], v55 offset:6144
s_waitcnt lgkmcnt(5)
v_mfma_f32_16x16x32_bf16 v[160:163], a[192:195], v[64:67], 0
ds_read_b128 v[92:95], v55 offset:7168
v_mfma_f32_16x16x32_bf16 v[164:167], a[196:199], v[64:67], 0
v_mfma_f32_16x16x32_bf16 v[160:163], a[200:203], v[68:71], v[160:163]
ds_read_b128 v[64:67], v55 offset:8192
v_mfma_f32_16x16x32_bf16 v[164:167], a[204:207], v[68:71], v[164:167]
s_waitcnt lgkmcnt(5)
v_mfma_f32_16x16x32_bf16 v[160:163], a[208:211], v[72:75], v[160:163]
ds_read_b128 v[68:71], v55 offset:9216
v_mfma_f32_16x16x32_bf16 v[164:167], a[212:215], v[72:75], v[164:167]
s_waitcnt vmcnt(4)
s_barrier
v_mfma_f32_16x16x32_bf16 v[160:163], a[216:219], v[76:79], v[160:163]
ds_read_b128 v[72:75], v55 offset:10240
v_mfma_f32_16x16x32_bf16 v[164:167], a[220:223], v[76:79], v[164:167]
ds_read_b64_tr_b16 a[224:225], v18 offset:0
s_waitcnt lgkmcnt(6)
v_mfma_f32_16x16x32_bf16 v[168:171], a[192:195], v[80:83], 0
ds_read_b128 v[76:79], v55 offset:11264
v_mfma_f32_16x16x32_bf16 v[172:175], a[196:199], v[80:83], 0
s_waitcnt vmcnt(0)
s_mov_b64 exec, 1
buffer_store_dwordx2 v[60:61], v155, s[20:23], 0 offen sc1
s_mov_b64 exec, -1
v_mfma_f32_16x16x32_bf16 v[168:171], a[200:203], v[84:87], v[168:171]
ds_read_b128 v[80:83], v55 offset:12288
v_mfma_f32_16x16x32_bf16 v[172:175], a[204:207], v[84:87], v[172:175]
s_add_u32 m0, s32, 16384
s_nop 0
buffer_load_dwordx4 v148, s[40:43], s80 offen offset:0 lds
ds_read_b64_tr_b16 a[226:227], v18 offset:4096
s_waitcnt lgkmcnt(7)
v_mfma_f32_16x16x32_bf16 v[168:171], a[208:211], v[88:91], v[168:171]
ds_read_b128 v[84:87], v55 offset:13312
v_mfma_f32_16x16x32_bf16 v[172:175], a[212:215], v[88:91], v[172:175]
buffer_load_dwordx4 v149, s[40:43], s80 offen offset:1024 lds
ds_read_b64_tr_b16 a[228:229], v19 offset:0
v_mfma_f32_16x16x32_bf16 v[168:171], a[216:219], v[92:95], v[168:171]
ds_read_b128 v[88:91], v55 offset:14336
v_mfma_f32_16x16x32_bf16 v[172:175], a[220:223], v[92:95], v[172:175]
buffer_load_dwordx4 v150, s[40:43], s80 offen offset:2048 lds
ds_read_b64_tr_b16 a[230:231], v19 offset:4096
ds_read_b64_tr_b16 a[232:233], v18 offset:8192
s_waitcnt lgkmcnt(10)
v_mfma_f32_16x16x32_bf16 v[176:179], a[192:195], v[64:67], 0
ds_read_b128 v[92:95], v55 offset:15360
v_mfma_f32_16x16x32_bf16 v[180:183], a[196:199], v[64:67], 0
buffer_load_dwordx4 v151, s[40:43], s80 offen offset:3072 lds
ds_read_b64_tr_b16 a[234:235], v18 offset:12288
ds_read_b64_tr_b16 a[236:237], v19 offset:8192
v_mfma_f32_16x16x32_bf16 v[176:179], a[200:203], v[68:71], v[176:179]
ds_read_b128 v[64:67], v55 offset:16384
v_mfma_f32_16x16x32_bf16 v[180:183], a[204:207], v[68:71], v[180:183]
s_add_u32 s30, s80, 131072
s_add_u32 m0, s32, 32768
s_nop 0
buffer_load_dwordx4 v148, s[40:43], s30 offen offset:0 lds
ds_read_b64_tr_b16 a[238:239], v19 offset:12288
ds_read_b64_tr_b16 a[240:241], v152 offset:32768
s_waitcnt lgkmcnt(13)
v_mfma_f32_16x16x32_bf16 v[176:179], a[208:211], v[72:75], v[176:179]
ds_read_b128 v[68:71], v55 offset:17408
v_mfma_f32_16x16x32_bf16 v[180:183], a[212:215], v[72:75], v[180:183]
buffer_load_dwordx4 v149, s[40:43], s30 offen offset:1024 lds
ds_read_b64_tr_b16 a[242:243], v152 offset:36864
ds_read_b64_tr_b16 a[244:245], v153 offset:32768
v_mfma_f32_16x16x32_bf16 v[176:179], a[216:219], v[76:79], v[176:179]
ds_read_b128 v[72:75], v55 offset:18432
v_mfma_f32_16x16x32_bf16 v[180:183], a[220:223], v[76:79], v[180:183]
buffer_load_dwordx4 v150, s[40:43], s30 offen offset:2048 lds
ds_read_b64_tr_b16 a[246:247], v153 offset:36864
ds_read_b64_tr_b16 a[248:249], v152 offset:40960
s_waitcnt lgkmcnt(15)
v_mfma_f32_16x16x32_bf16 v[184:187], a[192:195], v[80:83], 0
ds_read_b128 v[76:79], v55 offset:19456
v_mfma_f32_16x16x32_bf16 v[188:191], a[196:199], v[80:83], 0
buffer_load_dwordx4 v151, s[40:43], s30 offen offset:3072 lds
ds_read_b64_tr_b16 a[250:251], v152 offset:45056
ds_read_b64_tr_b16 a[252:253], v153 offset:40960
v_mfma_f32_16x16x32_bf16 v[184:187], a[200:203], v[84:87], v[184:187]
ds_read_b128 v[80:83], v55 offset:20480
v_mfma_f32_16x16x32_bf16 v[188:191], a[204:207], v[84:87], v[188:191]
ds_read_b64_tr_b16 a[254:255], v153 offset:45056
s_waitcnt lgkmcnt(15)
v_mfma_f32_16x16x32_bf16 v[184:187], a[208:211], v[88:91], v[184:187]
ds_read_b128 v[84:87], v55 offset:21504
v_mfma_f32_16x16x32_bf16 v[188:191], a[212:215], v[88:91], v[188:191]
v_mfma_f32_16x16x32_bf16 v[184:187], a[216:219], v[92:95], v[184:187]
ds_read_b128 v[88:91], v55 offset:22528
v_mfma_f32_16x16x32_bf16 v[188:191], a[220:223], v[92:95], v[188:191]
s_waitcnt lgkmcnt(12)
v_mfma_f32_16x16x32_bf16 v[192:195], a[192:195], v[64:67], 0
ds_read_b128 v[92:95], v55 offset:23552
v_mfma_f32_16x16x32_bf16 v[196:199], a[196:199], v[64:67], 0
v_mfma_f32_16x16x32_bf16 v[192:195], a[200:203], v[68:71], v[192:195]
ds_read_b128 v[64:67], v55 offset:24576
v_mfma_f32_16x16x32_bf16 v[196:199], a[204:207], v[68:71], v[196:199]
s_waitcnt lgkmcnt(8)
v_mfma_f32_16x16x32_bf16 v[192:195], a[208:211], v[72:75], v[192:195]
ds_read_b128 v[68:71], v55 offset:25600
v_mfma_f32_16x16x32_bf16 v[196:199], a[212:215], v[72:75], v[196:199]
v_mfma_f32_16x16x32_bf16 v[192:195], a[216:219], v[76:79], v[192:195]
ds_read_b128 v[72:75], v55 offset:26624
v_mfma_f32_16x16x32_bf16 v[196:199], a[220:223], v[76:79], v[196:199]
s_waitcnt lgkmcnt(5)
v_mfma_f32_16x16x32_bf16 v[200:203], a[192:195], v[80:83], 0
ds_read_b128 v[76:79], v55 offset:27648
v_mfma_f32_16x16x32_bf16 v[204:207], a[196:199], v[80:83], 0
s_barrier
v_mfma_f32_16x16x32_bf16 v[200:203], a[200:203], v[84:87], v[200:203]
ds_read_b128 v[80:83], v55 offset:28672
v_mfma_f32_16x16x32_bf16 v[204:207], a[204:207], v[84:87], v[204:207]
s_waitcnt lgkmcnt(5)
v_mfma_f32_16x16x32_bf16 v[200:203], a[208:211], v[88:91], v[200:203]
ds_read_b128 v[84:87], v55 offset:29696
v_mfma_f32_16x16x32_bf16 v[204:207], a[212:215], v[88:91], v[204:207]
v_mfma_f32_16x16x32_bf16 v[200:203], a[216:219], v[92:95], v[200:203]
ds_read_b128 v[88:91], v55 offset:30720
v_mfma_f32_16x16x32_bf16 v[204:207], a[220:223], v[92:95], v[204:207]
s_waitcnt lgkmcnt(5)
v_mfma_f32_16x16x32_bf16 v[208:211], a[192:195], v[64:67], 0
ds_read_b128 v[92:95], v55 offset:31744
v_mfma_f32_16x16x32_bf16 v[212:215], a[196:199], v[64:67], 0
v_mfma_f32_16x16x32_bf16 v[208:211], a[200:203], v[68:71], v[208:211]
ds_read_b128 v[64:67], v55 offset:32768
v_mfma_f32_16x16x32_bf16 v[212:215], a[204:207], v[68:71], v[212:215]
s_waitcnt lgkmcnt(5)
v_mfma_f32_16x16x32_bf16 v[208:211], a[208:211], v[72:75], v[208:211]
ds_read_b128 v[68:71], v55 offset:33792
v_mfma_f32_16x16x32_bf16 v[212:215], a[212:215], v[72:75], v[212:215]
buffer_load_dwordx2 v[62:63], v154, s[20:23], 0 offen sc1
v_mfma_f32_16x16x32_bf16 v[208:211], a[216:219], v[76:79], v[208:211]
ds_read_b128 v[72:75], v55 offset:34816
v_mfma_f32_16x16x32_bf16 v[212:215], a[220:223], v[76:79], v[212:215]
s_waitcnt lgkmcnt(5)
v_mfma_f32_16x16x32_bf16 v[216:219], a[192:195], v[80:83], 0
ds_read_b128 v[76:79], v55 offset:35840
v_mfma_f32_16x16x32_bf16 v[220:223], a[196:199], v[80:83], 0
v_mfma_f32_16x16x32_bf16 v[216:219], a[200:203], v[84:87], v[216:219]
ds_read_b128 v[80:83], v55 offset:36864
v_mfma_f32_16x16x32_bf16 v[220:223], a[204:207], v[84:87], v[220:223]
s_waitcnt lgkmcnt(5)
v_mfma_f32_16x16x32_bf16 v[216:219], a[208:211], v[88:91], v[216:219]
ds_read_b128 v[84:87], v55 offset:37888
v_mfma_f32_16x16x32_bf16 v[220:223], a[212:215], v[88:91], v[220:223]
v_mfma_f32_16x16x32_bf16 v[216:219], a[216:219], v[92:95], v[216:219]
ds_read_b128 v[88:91], v55 offset:38912
v_mfma_f32_16x16x32_bf16 v[220:223], a[220:223], v[92:95], v[220:223]
s_waitcnt lgkmcnt(5)
v_mfma_f32_16x16x32_bf16 v[224:227], a[192:195], v[64:67], 0
ds_read_b128 v[92:95], v55 offset:39936
v_mfma_f32_16x16x32_bf16 v[228:231], a[196:199], v[64:67], 0
v_mfma_f32_16x16x32_bf16 v[224:227], a[200:203], v[68:71], v[224:227]
ds_read_b128 v[64:67], v55 offset:40960
v_mfma_f32_16x16x32_bf16 v[228:231], a[204:207], v[68:71], v[228:231]
s_waitcnt lgkmcnt(5)
v_mfma_f32_16x16x32_bf16 v[224:227], a[208:211], v[72:75], v[224:227]
ds_read_b128 v[68:71], v55 offset:41984
v_mfma_f32_16x16x32_bf16 v[228:231], a[212:215], v[72:75], v[228:231]
v_mfma_f32_16x16x32_bf16 v[224:227], a[216:219], v[76:79], v[224:227]
ds_read_b128 v[72:75], v55 offset:43008
v_mfma_f32_16x16x32_bf16 v[228:231], a[220:223], v[76:79], v[228:231]
s_waitcnt lgkmcnt(5)
v_mfma_f32_16x16x32_bf16 v[232:235], a[192:195], v[80:83], 0
ds_read_b128 v[76:79], v55 offset:44032
v_mfma_f32_16x16x32_bf16 v[236:239], a[196:199], v[80:83], 0
s_waitcnt vmcnt(0)
v_cmp_eq_u64 vcc, v[62:63], v[60:61]
s_nop 3
s_mov_b32 s54, vcc_lo
s_bitcmp1_b32 s54, 1
s_cbranch_scc0 L_slow0
L_back0:
s_add_u32 m0, s71, 49152
s_nop 0
buffer_load_dwordx4 v8, s[20:23], s64 offen offset:0 sc1 lds
buffer_load_dwordx4 v8, s[20:23], s64 offen offset:1024 sc1 lds
buffer_load_dwordx4 v8, s[20:23], s64 offen offset:2048 sc1 lds
v_mfma_f32_16x16x32_bf16 v[232:235], a[200:203], v[84:87], v[232:235]
ds_read_b128 v[80:83], v55 offset:45056
v_mfma_f32_16x16x32_bf16 v[236:239], a[204:207], v[84:87], v[236:239]
s_bitcmp1_b32 s54, 9
s_cbranch_scc0 L_slow1
L_back1:
s_waitcnt lgkmcnt(5)
v_mfma_f32_16x16x32_bf16 v[232:235], a[208:211], v[88:91], v[232:235]
ds_read_b128 v[84:87], v55 offset:46080
v_mfma_f32_16x16x32_bf16 v[236:239], a[212:215], v[88:91], v[236:239]
s_add_u32 m0, s71, 61440
v_mfma_f32_16x16x32_bf16 v[232:235], a[216:219], v[92:95], v[232:235]
ds_read_b128 v[88:91], v55 offset:47104
v_mfma_f32_16x16x32_bf16 v[236:239], a[220:223], v[92:95], v[236:239]
buffer_load_dwordx4 v9, s[20:23], s64 offen offset:0 sc1 lds
s_waitcnt lgkmcnt(5)
v_mfma_f32_16x16x32_bf16 v[240:243], a[192:195], v[64:67], 0
ds_read_b128 v[92:95], v55 offset:48128
v_mfma_f32_16x16x32_bf16 v[244:247], a[196:199], v[64:67], 0
s_waitcnt vmcnt(1)
s_barrier
v_mfma_f32_16x16x32_bf16 v[240:243], a[200:203], v[68:71], v[240:243]
ds_read_b128 v[64:67], v53 offset:0
v_mfma_f32_16x16x32_bf16 v[244:247], a[204:207], v[68:71], v[244:247]
buffer_load_dwordx4 v9, s[20:23], s64 offen offset:1024 sc1 lds
s_waitcnt lgkmcnt(5)
v_mfma_f32_16x16x32_bf16 v[240:243], a[208:211], v[72:75], v[240:243]
ds_read_b128 v[68:71], v53 offset:1024
v_mfma_f32_16x16x32_bf16 v[244:247], a[212:215], v[72:75], v[244:247]
buffer_load_dwordx4 v9, s[20:23], s64 offen offset:2048 sc1 lds
s_bitcmp1_b32 s54, 2
s_cbranch_scc0 L_slow2
L_back2:
v_mfma_f32_16x16x32_bf16 v[240:243], a[216:219], v[76:79], v[240:243]
ds_read_b128 v[72:75], v53 offset:2048
v_mfma_f32_16x16x32_bf16 v[244:247], a[220:223], v[76:79], v[244:247]
s_add_u32 m0, s71, 73728
s_waitcnt lgkmcnt(5)
v_mfma_f32_16x16x32_bf16 v[248:251], a[192:195], v[80:83], 0
ds_read_b128 v[76:79], v53 offset:3072
v_mfma_f32_16x16x32_bf16 v[252:255], a[196:199], v[80:83], 0
buffer_load_dwordx4 v8, s[20:23], s65 offen offset:0 sc1 lds
v_mfma_f32_16x16x32_bf16 v[248:251], a[200:203], v[84:87], v[248:251]
ds_read_b128 v[80:83], v53 offset:4096
v_mfma_f32_16x16x32_bf16 v[252:255], a[204:207], v[84:87], v[252:255]
buffer_load_dwordx4 v8, s[20:23], s65 offen offset:1024 sc1 lds
s_waitcnt lgkmcnt(5)
v_mfma_f32_16x16x32_bf16 v[248:251], a[208:211], v[88:91], v[248:251]
ds_read_b128 v[84:87], v53 offset:5120
v_mfma_f32_16x16x32_bf16 v[252:255], a[212:215], v[88:91], v[252:255]
buffer_load_dwordx4 v8, s[20:23], s65 offen offset:2048 sc1 lds
v_mfma_f32_16x16x32_bf16 v[248:251], a[216:219], v[92:95], v[248:251]
ds_read_b128 v[88:91], v53 offset:6144
v_mfma_f32_16x16x32_bf16 v[252:255], a[220:223], v[92:95], v[252:255]
s_bitcmp1_b32 s54, 10
s_cbranch_scc0 L_slow3
L_back3:
s_waitcnt lgkmcnt(5)
v_mfma_f32_16x16x32_bf16 v[160:163], a[224:227], v[64:67], v[160:163]
ds_read_b128 v[92:95], v53 offset:7168
v_mfma_f32_16x16x32_bf16 v[164:167], a[228:231], v[64:67], v[164:167]
s_add_u32 m0, s71, 86016
v_mfma_f32_16x16x32_bf16 v[160:163], a[232:235], v[68:71], v[160:163]
ds_read_b128 v[64:67], v53 offset:8192
v_mfma_f32_16x16x32_bf16 v[164:167], a[236:239], v[68:71], v[164:167]
buffer_load_dwordx4 v9, s[20:23], s65 offen offset:0 sc1 lds
s_waitcnt lgkmcnt(5)
v_mfma_f32_16x16x32_bf16 v[160:163], a[240:243], v[72:75], v[160:163]
ds_read_b128 v[68:71], v53 offset:9216
v_mfma_f32_16x16x32_bf16 v[164:167], a[244:247], v[72:75], v[164:167]
buffer_load_dwordx4 v9, s[20:23], s65 offen offset:1024 sc1 lds
v_mfma_f32_16x16x32_bf16 v[160:163], a[248:251], v[76:79], v[160:163]
ds_read_b128 v[72:75], v53 offset:10240
v_mfma_f32_16x16x32_bf16 v[164:167], a[252:255], v[76:79], v[164:167]
buffer_load_dwordx4 v9, s[20:23], s65 offen offset:2048 sc1 lds
s_waitcnt lgkmcnt(5)
v_mfma_f32_16x16x32_bf16 v[168:171], a[224:227], v[80:83], v[168:171]
ds_read_b128 v[76:79], v53 offset:11264
v_mfma_f32_16x16x32_bf16 v[172:175], a[228:231], v[80:83], v[172:175]
s_waitcnt vmcnt(6)
s_barrier
v_mfma_f32_16x16x32_bf16 v[168:171], a[232:235], v[84:87], v[168:171]
ds_read_b128 v[80:83], v53 offset:12288
v_mfma_f32_16x16x32_bf16 v[172:175], a[236:239], v[84:87], v[172:175]
s_add_u32 m0, s32, 0
s_nop 0
buffer_load_dwordx4 v148, s[40:43], s81 offen offset:0 lds
ds_read_b64_tr_b16 a[0:1], v18 offset:16384
s_waitcnt lgkmcnt(6)
v_mfma_f32_16x16x32_bf16 v[168:171], a[240:243], v[88:91], v[168:171]
ds_read_b128 v[84:87], v53 offset:13312
v_mfma_f32_16x16x32_bf16 v[172:175], a[244:247], v[88:91], v[172:175]
buffer_load_dwordx4 v149, s[40:43], s81 offen offset:1024 lds
ds_read_b64_tr_b16 a[2:3], v18 offset:20480
v_mfma_f32_16x16x32_bf16 v[168:171], a[248:251], v[92:95], v[168:171]
ds_read_b128 v[88:91], v53 offset:14336
v_mfma_f32_16x16x32_bf16 v[172:175], a[252:255], v[92:95], v[172:175]
buffer_load_dwordx4 v150, s[40:43], s81 offen offset:2048 lds
ds_read_b64_tr_b16 a[4:5], v19 offset:16384
s_waitcnt lgkmcnt(8)
v_mfma_f32_16x16x32_bf16 v[176:179], a[224:227], v[64:67], v[176:179]
ds_read_b128 v[92:95], v53 offset:15360
v_mfma_f32_16x16x32_bf16 v[180:183], a[228:231], v[64:67], v[180:183]
buffer_load_dwordx4 v151, s[40:43], s81 offen offset:3072 lds
ds_read_b64_tr_b16 a[6:7], v19 offset:20480
v_mfma_f32_16x16x32_bf16 v[176:179], a[232:235], v[68:71], v[176:179]
ds_read_b128 v[64:67], v53 offset:16384
v_mfma_f32_16x16x32_bf16 v[180:183], a[236:239], v[68:71], v[180:183]
s_bitcmp1_b32 s54, 3
s_cbranch_scc0 L_slow4
L_back4:
ds_read_b64_tr_b16 a[8:9], v18 offset:24576
s_waitcnt lgkmcnt(10)
v_mfma_f32_16x16x32_bf16 v[176:179], a[240:243], v[72:75], v[176:179]
ds_read_b128 v[68:71], v53 offset:17408
v_mfma_f32_16x16x32_bf16 v[180:183], a[244:247], v[72:75], v[180:183]
s_add_u32 m0, s71, 106496
ds_read_b64_tr_b16 a[10:11], v18 offset:28672
v_mfma_f32_16x16x32_bf16 v[176:179], a[248:251], v[76:79], v[176:179]
ds_read_b128 v[72:75], v53 offset:18432
v_mfma_f32_16x16x32_bf16 v[180:183], a[252:255], v[76:79], v[180:183]
buffer_load_dwordx4 v8, s[20:23], s66 offen offset:0 sc1 lds
ds_read_b64_tr_b16 a[12:13], v19 offset:24576
s_waitcnt lgkmcnt(11)
v_mfma_f32_16x16x32_bf16 v[184:187], a[224:227], v[80:83], v[184:187]
ds_read_b128 v[76:79], v53 offset:19456
v_mfma_f32_16x16x32_bf16 v[188:191], a[228:231], v[80:83], v[188:191]
buffer_load_dwordx4 v8, s[20:23], s66 offen offset:1024 sc1 lds
ds_read_b64_tr_b16 a[14:15], v19 offset:28672
v_mfma_f32_16x16x32_bf16 v[184:187], a[232:235], v[84:87], v[184:187]
ds_read_b128 v[80:83], v53 offset:20480
v_mfma_f32_16x16x32_bf16 v[188:191], a[236:239], v[84:87], v[188:191]
buffer_load_dwordx4 v8, s[20:23], s66 offen offset:2048 sc1 lds
s_waitcnt lgkmcnt(10)
v_mfma_f32_16x16x32_bf16 v[184:187], a[240:243], v[88:91], v[184:187]
ds_read_b128 v[84:87], v53 offset:21504
v_mfma_f32_16x16x32_bf16 v[188:191], a[244:247], v[88:91], v[188:191]
v_mfma_f32_16x16x32_bf16 v[184:187], a[248:251], v[92:95], v[184:187]
ds_read_b128 v[88:91], v53 offset:22528
v_mfma_f32_16x16x32_bf16 v[188:191], a[252:255], v[92:95], v[188:191]
s_waitcnt lgkmcnt(8)
v_mfma_f32_16x16x32_bf16 v[192:195], a[224:227], v[64:67], v[192:195]
ds_read_b128 v[92:95], v53 offset:23552
v_mfma_f32_16x16x32_bf16 v[196:199], a[228:231], v[64:67], v[196:199]
s_waitcnt lgkmcnt(4)
s_waitcnt vmcnt(10)
s_barrier
v_mfma_f32_16x16x32_bf16 v[192:195], a[232:235], v[68:71], v[192:195]
ds_read_b128 v[64:67], v53 offset:24576
v_mfma_f32_16x16x32_bf16 v[196:199], a[236:239], v[68:71], v[196:199]
s_add_u32 s30, s81, 131072
s_add_u32 m0, s32, 16384
s_nop 0
buffer_load_dwordx4 v148, s[40:43], s30 offen offset:0 lds
ds_read_b64_tr_b16 a[16:17], v18 offset:32768
v_mfma_f32_16x16x32_bf16 v[192:195], a[240:243], v[72:75], v[192:195]
ds_read_b128 v[68:71], v53 offset:25600
v_mfma_f32_16x16x32_bf16 v[196:199], a[244:247], v[72:75], v[196:199]
buffer_load_dwordx4 v149, s[40:43], s30 offen offset:1024 lds
ds_read_b64_tr_b16 a[18:19], v18 offset:36864
v_mfma_f32_16x16x32_bf16 v[192:195], a[248:251], v[76:79], v[192:195]
ds_read_b128 v[72:75], v53 offset:26624
v_mfma_f32_16x16x32_bf16 v[196:199], a[252:255], v[76:79], v[196:199]
buffer_load_dwordx4 v150, s[40:43], s30 offen offset:2048 lds
ds_read_b64_tr_b16 a[20:21], v19 offset:32768
s_waitcnt lgkmcnt(8)
v_mfma_f32_16x16x32_bf16 v[200:203], a[224:227], v[80:83], v[200:203]
ds_read_b128 v[76:79], v53 offset:27648
v_mfma_f32_16x16x32_bf16 v[204:207], a[228:231], v[80:83], v[204:207]
buffer_load_dwordx4 v151, s[40:43], s30 offen offset:3072 lds
ds_read_b64_tr_b16 a[22:23], v19 offset:36864
v_mfma_f32_16x16x32_bf16 v[200:203], a[232:235], v[84:87], v[200:203]
ds_read_b128 v[80:83], v53 offset:28672
v_mfma_f32_16x16x32_bf16 v[204:207], a[236:239], v[84:87], v[204:207]
s_bitcmp1_b32 s54, 11
s_cbranch_scc0 L_slow5
L_back5:
ds_read_b64_tr_b16 a[24:25], v18 offset:40960
s_waitcnt lgkmcnt(10)
v_mfma_f32_16x16x32_bf16 v[200:203], a[240:243], v[88:91], v[200:203]
ds_read_b128 v[84:87], v53 offset:29696
v_mfma_f32_16x16x32_bf16 v[204:207], a[244:247], v[88:91], v[204:207]
s_add_u32 m0, s71, 118784
ds_read_b64_tr_b16 a[26:27], v18 offset:45056
v_mfma_f32_16x16x32_bf16 v[200:203], a[248:251], v[92:95], v[200:203]
ds_read_b128 v[88:91], v53 offset:30720
v_mfma_f32_16x16x32_bf16 v[204:207], a[252:255], v[92:95], v[204:207]
buffer_load_dwordx4 v9, s[20:23], s66 offen offset:0 sc1 lds
ds_read_b64_tr_b16 a[28:29], v19 offset:40960
s_waitcnt lgkmcnt(11)
v_mfma_f32_16x16x32_bf16 v[160:163], a[0:3], v[64:67], v[160:163]
ds_read_b128 v[92:95], v53 offset:31744
v_mfma_f32_16x16x32_bf16 v[164:167], a[4:7], v[64:67], v[164:167]
buffer_load_dwordx4 v9, s[20:23], s66 offen offset:1024 sc1 lds
ds_read_b64_tr_b16 a[30:31], v19 offset:45056
v_mfma_f32_16x16x32_bf16 v[160:163], a[8:11], v[68:71], v[160:163]
ds_read_b128 v[64:67], v53 offset:32768
v_mfma_f32_16x16x32_bf16 v[164:167], a[12:15], v[68:71], v[164:167]
buffer_load_dwordx4 v9, s[20:23], s66 offen offset:2048 sc1 lds
s_waitcnt lgkmcnt(1)
v_mfma_f32_16x16x32_bf16 v[160:163], a[16:19], v[72:75], v[160:163]
ds_read_b128 v[68:71], v53 offset:33792
v_mfma_f32_16x16x32_bf16 v[164:167], a[20:23], v[72:75], v[164:167]
v_mfma_f32_16x16x32_bf16 v[160:163], a[24:27], v[76:79], v[160:163]
ds_read_b128 v[72:75], v53 offset:34816
v_mfma_f32_16x16x32_bf16 v[164:167], a[28:31], v[76:79], v[164:167]
v_mfma_f32_16x16x32_bf16 v[168:171], a[0:3], v[80:83], v[168:171]
ds_read_b128 v[76:79], v53 offset:35840
v_mfma_f32_16x16x32_bf16 v[172:175], a[4:7], v[80:83], v[172:175]
s_waitcnt vmcnt(10)
s_barrier
v_mfma_f32_16x16x32_bf16 v[168:171], a[8:11], v[84:87], v[168:171]
ds_read_b128 v[80:83], v53 offset:36864
v_mfma_f32_16x16x32_bf16 v[172:175], a[12:15], v[84:87], v[172:175]
s_add_u32 m0, s32, 32768
s_nop 0
buffer_load_dwordx4 v148, s[40:43], s82 offen offset:0 lds
ds_read_b64_tr_b16 a[32:33], v18 offset:0
v_mfma_f32_16x16x32_bf16 v[168:171], a[16:19], v[88:91], v[168:171]
ds_read_b128 v[84:87], v53 offset:37888
v_mfma_f32_16x16x32_bf16 v[172:175], a[20:23], v[88:91], v[172:175]
buffer_load_dwordx4 v149, s[40:43], s82 offen offset:1024 lds
ds_read_b64_tr_b16 a[34:35], v18 offset:4096
v_mfma_f32_16x16x32_bf16 v[168:171], a[24:27], v[92:95], v[168:171]
ds_read_b128 v[88:91], v53 offset:38912
v_mfma_f32_16x16x32_bf16 v[172:175], a[28:31], v[92:95], v[172:175]
buffer_load_dwordx4 v150, s[40:43], s82 offen offset:2048 lds
ds_read_b64_tr_b16 a[36:37], v19 offset:0
s_waitcnt lgkmcnt(8)
v_mfma_f32_16x16x32_bf16 v[176:179], a[0:3], v[64:67], v[176:179]
ds_read_b128 v[92:95], v53 offset:39936
v_mfma_f32_16x16x32_bf16 v[180:183], a[4:7], v[64:67], v[180:183]
buffer_load_dwordx4 v151, s[40:43], s82 offen offset:3072 lds
ds_read_b64_tr_b16 a[38:39], v19 offset:4096
v_mfma_f32_16x16x32_bf16 v[176:179], a[8:11], v[68:71], v[176:179]
ds_read_b128 v[64:67], v53 offset:40960
v_mfma_f32_16x16x32_bf16 v[180:183], a[12:15], v[68:71], v[180:183]
s_bitcmp1_b32 s54, 4
s_cbranch_scc0 L_slow6
L_back6:
ds_read_b64_tr_b16 a[40:41], v18 offset:8192
s_waitcnt lgkmcnt(10)
v_mfma_f32_16x16x32_bf16 v[176:179], a[16:19], v[72:75], v[176:179]
ds_read_b128 v[68:71], v53 offset:41984
v_mfma_f32_16x16x32_bf16 v[180:183], a[20:23], v[72:75], v[180:183]
s_add_u32 m0, s71, 131072
ds_read_b64_tr_b16 a[42:43], v18 offset:12288
v_mfma_f32_16x16x32_bf16 v[176:179], a[24:27], v[76:79], v[176:179]
ds_read_b128 v[72:75], v53 offset:43008
v_mfma_f32_16x16x32_bf16 v[180:183], a[28:31], v[76:79], v[180:183]
buffer_load_dwordx4 v8, s[20:23], s67 offen offset:0 sc1 lds
ds_read_b64_tr_b16 a[44:45], v19 offset:8192
s_waitcnt lgkmcnt(11)
v_mfma_f32_16x16x32_bf16 v[184:187], a[0:3], v[80:83], v[184:187]
ds_read_b128 v[76:79], v53 offset:44032
v_mfma_f32_16x16x32_bf16 v[188:191], a[4:7], v[80:83], v[188:191]
buffer_load_dwordx4 v8, s[20:23], s67 offen offset:1024 sc1 lds
ds_read_b64_tr_b16 a[46:47], v19 offset:12288
v_mfma_f32_16x16x32_bf16 v[184:187], a[8:11], v[84:87], v[184:187]
ds_read_b128 v[80:83], v53 offset:45056
v_mfma_f32_16x16x32_bf16 v[188:191], a[12:15], v[84:87], v[188:191]
buffer_load_dwordx4 v8, s[20:23], s67 offen offset:2048 sc1 lds
s_waitcnt lgkmcnt(10)
v_mfma_f32_16x16x32_bf16 v[184:187], a[16:19], v[88:91], v[184:187]
ds_read_b128 v[84:87], v53 offset:46080
v_mfma_f32_16x16x32_bf16 v[188:191], a[20:23], v[88:91], v[188:191]
v_mfma_f32_16x16x32_bf16 v[184:187], a[24:27], v[92:95], v[184:187]
ds_read_b128 v[88:91], v53 offset:47104
v_mfma_f32_16x16x32_bf16 v[188:191], a[28:31], v[92:95], v[188:191]
s_waitcnt lgkmcnt(8)
v_mfma_f32_16x16x32_bf16 v[192:195], a[0:3], v[64:67], v[192:195]
ds_read_b128 v[92:95], v53 offset:48128
v_mfma_f32_16x16x32_bf16 v[196:199], a[4:7], v[64:67], v[196:199]
s_waitcnt lgkmcnt(4)
s_waitcnt vmcnt(10)
s_barrier
v_mfma_f32_16x16x32_bf16 v[192:195], a[8:11], v[68:71], v[192:195]
ds_read_b128 v[64:67], v55 offset:0
v_mfma_f32_16x16x32_bf16 v[196:199], a[12:15], v[68:71], v[196:199]
s_add_u32 s30, s82, 131072
s_add_u32 m0, s32, 0
s_nop 0
buffer_load_dwordx4 v148, s[40:43], s30 offen offset:0 lds
ds_read_b64_tr_b16 a[48:49], v18 offset:16384
v_mfma_f32_16x16x32_bf16 v[192:195], a[16:19], v[72:75], v[192:195]
ds_read_b128 v[68:71], v55 offset:1024
v_mfma_f32_16x16x32_bf16 v[196:199], a[20:23], v[72:75], v[196:199]
buffer_load_dwordx4 v149, s[40:43], s30 offen offset:1024 lds
ds_read_b64_tr_b16 a[50:51], v18 offset:20480
v_mfma_f32_16x16x32_bf16 v[192:195], a[24:27], v[76:79], v[192:195]
ds_read_b128 v[72:75], v55 offset:2048
v_mfma_f32_16x16x32_bf16 v[196:199], a[28:31], v[76:79], v[196:199]
buffer_load_dwordx4 v150, s[40:43], s30 offen offset:2048 lds
ds_read_b64_tr_b16 a[52:53], v19 offset:16384
s_waitcnt lgkmcnt(8)
v_mfma_f32_16x16x32_bf16 v[200:203], a[0:3], v[80:83], v[200:203]
ds_read_b128 v[76:79], v55 offset:3072
v_mfma_f32_16x16x32_bf16 v[204:207], a[4:7], v[80:83], v[204:207]
buffer_load_dwordx4 v151, s[40:43], s30 offen offset:3072 lds
ds_read_b64_tr_b16 a[54:55], v19 offset:20480
v_mfma_f32_16x16x32_bf16 v[200:203], a[8:11], v[84:87], v[200:203]
ds_read_b128 v[80:83], v55 offset:4096
v_mfma_f32_16x16x32_bf16 v[204:207], a[12:15], v[84:87], v[204:207]
s_bitcmp1_b32 s54, 12
s_cbranch_scc0 L_slow7
L_back7:
ds_read_b64_tr_b16 a[56:57], v18 offset:24576
s_waitcnt lgkmcnt(10)
v_mfma_f32_16x16x32_bf16 v[200:203], a[16:19], v[88:91], v[200:203]
ds_read_b128 v[84:87], v55 offset:5120
v_mfma_f32_16x16x32_bf16 v[204:207], a[20:23], v[88:91], v[204:207]
s_add_u32 m0, s71, 143360
ds_read_b64_tr_b16 a[58:59], v18 offset:28672
v_mfma_f32_16x16x32_bf16 v[200:203], a[24:27], v[92:95], v[200:203]
ds_read_b128 v[88:91], v55 offset:6144
v_mfma_f32_16x16x32_bf16 v[204:207], a[28:31], v[92:95], v[204:207]
buffer_load_dwordx4 v9, s[20:23], s67 offen offset:0 sc1 lds
ds_read_b64_tr_b16 a[60:61], v19 offset:24576
s_waitcnt lgkmcnt(11)
v_mfma_f32_16x16x32_bf16 v[160:163], a[32:35], v[64:67], v[160:163]
ds_read_b128 v[92:95], v55 offset:7168
v_mfma_f32_16x16x32_bf16 v[164:167], a[36:39], v[64:67], v[164:167]
buffer_load_dwordx4 v9, s[20:23], s67 offen offset:1024 sc1 lds
ds_read_b64_tr_b16 a[62:63], v19 offset:28672
v_mfma_f32_16x16x32_bf16 v[160:163], a[40:43], v[68:71], v[160:163]
ds_read_b128 v[64:67], v55 offset:8192
v_mfma_f32_16x16x32_bf16 v[164:167], a[44:47], v[68:71], v[164:167]
buffer_load_dwordx4 v9, s[20:23], s67 offen offset:2048 sc1 lds
s_waitcnt lgkmcnt(1)
v_mfma_f32_16x16x32_bf16 v[160:163], a[48:51], v[72:75], v[160:163]
ds_read_b128 v[68:71], v55 offset:9216
v_mfma_f32_16x16x32_bf16 v[164:167], a[52:55], v[72:75], v[164:167]
v_mfma_f32_16x16x32_bf16 v[160:163], a[56:59], v[76:79], v[160:163]
ds_read_b128 v[72:75], v55 offset:10240
v_mfma_f32_16x16x32_bf16 v[164:167], a[60:63], v[76:79], v[164:167]
v_mfma_f32_16x16x32_bf16 v[168:171], a[32:35], v[80:83], v[168:171]
ds_read_b128 v[76:79], v55 offset:11264
v_mfma_f32_16x16x32_bf16 v[172:175], a[36:39], v[80:83], v[172:175]
s_waitcnt vmcnt(10)
s_barrier
v_mfma_f32_16x16x32_bf16 v[168:171], a[40:43], v[84:87], v[168:171]
ds_read_b128 v[80:83], v55 offset:12288
v_mfma_f32_16x16x32_bf16 v[172:175], a[44:47], v[84:87], v[172:175]
s_add_u32 m0, s32, 16384
s_nop 0
buffer_load_dwordx4 v148, s[40:43], s83 offen offset:0 lds
ds_read_b64_tr_b16 a[64:65], v18 offset:32768
v_mfma_f32_16x16x32_bf16 v[168:171], a[48:51], v[88:91], v[168:171]
ds_read_b128 v[84:87], v55 offset:13312
v_mfma_f32_16x16x32_bf16 v[172:175], a[52:55], v[88:91], v[172:175]
buffer_load_dwordx4 v149, s[40:43], s83 offen offset:1024 lds
ds_read_b64_tr_b16 a[66:67], v18 offset:36864
v_mfma_f32_16x16x32_bf16 v[168:171], a[56:59], v[92:95], v[168:171]
ds_read_b128 v[88:91], v55 offset:14336
v_mfma_f32_16x16x32_bf16 v[172:175], a[60:63], v[92:95], v[172:175]
buffer_load_dwordx4 v150, s[40:43], s83 offen offset:2048 lds
ds_read_b64_tr_b16 a[68:69], v19 offset:32768
s_waitcnt lgkmcnt(8)
v_mfma_f32_16x16x32_bf16 v[176:179], a[32:35], v[64:67], v[176:179]
ds_read_b128 v[92:95], v55 offset:15360
v_mfma_f32_16x16x32_bf16 v[180:183], a[36:39], v[64:67], v[180:183]
buffer_load_dwordx4 v151, s[40:43], s83 offen offset:3072 lds
ds_read_b64_tr_b16 a[70:71], v19 offset:36864
v_mfma_f32_16x16x32_bf16 v[176:179], a[40:43], v[68:71], v[176:179]
ds_read_b128 v[64:67], v55 offset:16384
v_mfma_f32_16x16x32_bf16 v[180:183], a[44:47], v[68:71], v[180:183]
s_bitcmp1_b32 s54, 5
s_cbranch_scc0 L_slow8
L_back8:
ds_read_b64_tr_b16 a[72:73], v18 offset:40960
s_waitcnt lgkmcnt(10)
v_mfma_f32_16x16x32_bf16 v[176:179], a[48:51], v[72:75], v[176:179]
ds_read_b128 v[68:71], v55 offset:17408
v_mfma_f32_16x16x32_bf16 v[180:183], a[52:55], v[72:75], v[180:183]
s_add_u32 m0, s71, 49152
ds_read_b64_tr_b16 a[74:75], v18 offset:45056
v_mfma_f32_16x16x32_bf16 v[176:179], a[56:59], v[76:79], v[176:179]
ds_read_b128 v[72:75], v55 offset:18432
v_mfma_f32_16x16x32_bf16 v[180:183], a[60:63], v[76:79], v[180:183]
buffer_load_dwordx4 v8, s[20:23], s68 offen offset:0 sc1 lds
ds_read_b64_tr_b16 a[76:77], v19 offset:40960
s_waitcnt lgkmcnt(11)
v_mfma_f32_16x16x32_bf16 v[184:187], a[32:35], v[80:83], v[184:187]
ds_read_b128 v[76:79], v55 offset:19456
v_mfma_f32_16x16x32_bf16 v[188:191], a[36:39], v[80:83], v[188:191]
buffer_load_dwordx4 v8, s[20:23], s68 offen offset:1024 sc1 lds
ds_read_b64_tr_b16 a[78:79], v19 offset:45056
v_mfma_f32_16x16x32_bf16 v[184:187], a[40:43], v[84:87], v[184:187]
ds_read_b128 v[80:83], v55 offset:20480
v_mfma_f32_16x16x32_bf16 v[188:191], a[44:47], v[84:87], v[188:191]
buffer_load_dwordx4 v8, s[20:23], s68 offen offset:2048 sc1 lds
s_waitcnt lgkmcnt(10)
v_mfma_f32_16x16x32_bf16 v[184:187], a[48:51], v[88:91], v[184:187]
ds_read_b128 v[84:87], v55 offset:21504
v_mfma_f32_16x16x32_bf16 v[188:191], a[52:55], v[88:91], v[188:191]
v_mfma_f32_16x16x32_bf16 v[184:187], a[56:59], v[92:95], v[184:187]
ds_read_b128 v[88:91], v55 offset:22528
v_mfma_f32_16x16x32_bf16 v[188:191], a[60:63], v[92:95], v[188:191]
s_waitcnt lgkmcnt(8)
v_mfma_f32_16x16x32_bf16 v[192:195], a[32:35], v[64:67], v[192:195]
ds_read_b128 v[92:95], v55 offset:23552
v_mfma_f32_16x16x32_bf16 v[196:199], a[36:39], v[64:67], v[196:199]
s_waitcnt lgkmcnt(4)
s_waitcnt vmcnt(10)
s_barrier
v_mfma_f32_16x16x32_bf16 v[192:195], a[40:43], v[68:71], v[192:195]
ds_read_b128 v[64:67], v55 offset:24576
v_mfma_f32_16x16x32_bf16 v[196:199], a[44:47], v[68:71], v[196:199]
s_add_u32 s30, s83, 131072
s_add_u32 m0, s32, 32768
s_nop 0
buffer_load_dwordx4 v148, s[40:43], s30 offen offset:0 lds
ds_read_b64_tr_b16 a[80:81], v18 offset:0
v_mfma_f32_16x16x32_bf16 v[192:195], a[48:51], v[72:75], v[192:195]
ds_read_b128 v[68:71], v55 offset:25600
v_mfma_f32_16x16x32_bf16 v[196:199], a[52:55], v[72:75], v[196:199]
buffer_load_dwordx4 v149, s[40:43], s30 offen offset:1024 lds
ds_read_b64_tr_b16 a[82:83], v18 offset:4096
v_mfma_f32_16x16x32_bf16 v[192:195], a[56:59], v[76:79], v[192:195]
ds_read_b128 v[72:75], v55 offset:26624
v_mfma_f32_16x16x32_bf16 v[196:199], a[60:63], v[76:79], v[196:199]
buffer_load_dwordx4 v150, s[40:43], s30 offen offset:2048 lds
ds_read_b64_tr_b16 a[84:85], v19 offset:0
s_waitcnt lgkmcnt(8)
v_mfma_f32_16x16x32_bf16 v[200:203], a[32:35], v[80:83], v[200:203]
ds_read_b128 v[76:79], v55 offset:27648
v_mfma_f32_16x16x32_bf16 v[204:207], a[36:39], v[80:83], v[204:207]
buffer_load_dwordx4 v151, s[40:43], s30 offen offset:3072 lds
ds_read_b64_tr_b16 a[86:87], v19 offset:4096
v_mfma_f32_16x16x32_bf16 v[200:203], a[40:43], v[84:87], v[200:203]
ds_read_b128 v[80:83], v55 offset:28672
v_mfma_f32_16x16x32_bf16 v[204:207], a[44:47], v[84:87], v[204:207]
s_bitcmp1_b32 s54, 13
s_cbranch_scc0 L_slow9
L_back9:
ds_read_b64_tr_b16 a[88:89], v18 offset:8192
s_waitcnt lgkmcnt(10)
v_mfma_f32_16x16x32_bf16 v[200:203], a[48:51], v[88:91], v[200:203]
ds_read_b128 v[84:87], v55 offset:29696
v_mfma_f32_16x16x32_bf16 v[204:207], a[52:55], v[88:91], v[204:207]
s_add_u32 m0, s71, 61440
ds_read_b64_tr_b16 a[90:91], v18 offset:12288
v_mfma_f32_16x16x32_bf16 v[200:203], a[56:59], v[92:95], v[200:203]
ds_read_b128 v[88:91], v55 offset:30720
v_mfma_f32_16x16x32_bf16 v[204:207], a[60:63], v[92:95], v[204:207]
buffer_load_dwordx4 v9, s[20:23], s68 offen offset:0 sc1 lds
ds_read_b64_tr_b16 a[92:93], v19 offset:8192
s_waitcnt lgkmcnt(11)
v_mfma_f32_16x16x32_bf16 v[160:163], a[64:67], v[64:67], v[160:163]
ds_read_b128 v[92:95], v55 offset:31744
v_mfma_f32_16x16x32_bf16 v[164:167], a[68:71], v[64:67], v[164:167]
buffer_load_dwordx4 v9, s[20:23], s68 offen offset:1024 sc1 lds
ds_read_b64_tr_b16 a[94:95], v19 offset:12288
v_mfma_f32_16x16x32_bf16 v[160:163], a[72:75], v[68:71], v[160:163]
ds_read_b128 v[64:67], v55 offset:32768
v_mfma_f32_16x16x32_bf16 v[164:167], a[76:79], v[68:71], v[164:167]
buffer_load_dwordx4 v9, s[20:23], s68 offen offset:2048 sc1 lds
s_waitcnt lgkmcnt(1)
v_mfma_f32_16x16x32_bf16 v[160:163], a[80:83], v[72:75], v[160:163]
ds_read_b128 v[68:71], v55 offset:33792
v_mfma_f32_16x16x32_bf16 v[164:167], a[84:87], v[72:75], v[164:167]
v_mfma_f32_16x16x32_bf16 v[160:163], a[88:91], v[76:79], v[160:163]
ds_read_b128 v[72:75], v55 offset:34816
v_mfma_f32_16x16x32_bf16 v[164:167], a[92:95], v[76:79], v[164:167]
v_mfma_f32_16x16x32_bf16 v[168:171], a[64:67], v[80:83], v[168:171]
ds_read_b128 v[76:79], v55 offset:35840
v_mfma_f32_16x16x32_bf16 v[172:175], a[68:71], v[80:83], v[172:175]
s_waitcnt vmcnt(10)
s_barrier
v_mfma_f32_16x16x32_bf16 v[168:171], a[72:75], v[84:87], v[168:171]
ds_read_b128 v[80:83], v55 offset:36864
v_mfma_f32_16x16x32_bf16 v[172:175], a[76:79], v[84:87], v[172:175]
s_add_u32 m0, s32, 0
s_nop 0
buffer_load_dwordx4 v148, s[40:43], s84 offen offset:0 lds
ds_read_b64_tr_b16 a[96:97], v18 offset:16384
v_mfma_f32_16x16x32_bf16 v[168:171], a[80:83], v[88:91], v[168:171]
ds_read_b128 v[84:87], v55 offset:37888
v_mfma_f32_16x16x32_bf16 v[172:175], a[84:87], v[88:91], v[172:175]
buffer_load_dwordx4 v149, s[40:43], s84 offen offset:1024 lds
ds_read_b64_tr_b16 a[98:99], v18 offset:20480
v_mfma_f32_16x16x32_bf16 v[168:171], a[88:91], v[92:95], v[168:171]
ds_read_b128 v[88:91], v55 offset:38912
v_mfma_f32_16x16x32_bf16 v[172:175], a[92:95], v[92:95], v[172:175]
buffer_load_dwordx4 v150, s[40:43], s84 offen offset:2048 lds
ds_read_b64_tr_b16 a[100:101], v19 offset:16384
s_waitcnt lgkmcnt(8)
v_mfma_f32_16x16x32_bf16 v[176:179], a[64:67], v[64:67], v[176:179]
ds_read_b128 v[92:95], v55 offset:39936
v_mfma_f32_16x16x32_bf16 v[180:183], a[68:71], v[64:67], v[180:183]
buffer_load_dwordx4 v151, s[40:43], s84 offen offset:3072 lds
ds_read_b64_tr_b16 a[102:103], v19 offset:20480
v_mfma_f32_16x16x32_bf16 v[176:179], a[72:75], v[68:71], v[176:179]
ds_read_b128 v[64:67], v55 offset:40960
v_mfma_f32_16x16x32_bf16 v[180:183], a[76:79], v[68:71], v[180:183]
s_bitcmp1_b32 s54, 6
s_cbranch_scc0 L_slow10
L_back10:
ds_read_b64_tr_b16 a[104:105], v18 offset:24576
s_waitcnt lgkmcnt(10)
v_mfma_f32_16x16x32_bf16 v[176:179], a[80:83], v[72:75], v[176:179]
ds_read_b128 v[68:71], v55 offset:41984
v_mfma_f32_16x16x32_bf16 v[180:183], a[84:87], v[72:75], v[180:183]
s_add_u32 m0, s71, 73728
ds_read_b64_tr_b16 a[106:107], v18 offset:28672
v_mfma_f32_16x16x32_bf16 v[176:179], a[88:91], v[76:79], v[176:179]
ds_read_b128 v[72:75], v55 offset:43008
v_mfma_f32_16x16x32_bf16 v[180:183], a[92:95], v[76:79], v[180:183]
buffer_load_dwordx4 v8, s[20:23], s69 offen offset:0 sc1 lds
ds_read_b64_tr_b16 a[108:109], v19 offset:24576
s_waitcnt lgkmcnt(11)
v_mfma_f32_16x16x32_bf16 v[184:187], a[64:67], v[80:83], v[184:187]
ds_read_b128 v[76:79], v55 offset:44032
v_mfma_f32_16x16x32_bf16 v[188:191], a[68:71], v[80:83], v[188:191]
buffer_load_dwordx4 v8, s[20:23], s69 offen offset:1024 sc1 lds
ds_read_b64_tr_b16 a[110:111], v19 offset:28672
v_mfma_f32_16x16x32_bf16 v[184:187], a[72:75], v[84:87], v[184:187]
ds_read_b128 v[80:83], v55 offset:45056
v_mfma_f32_16x16x32_bf16 v[188:191], a[76:79], v[84:87], v[188:191]
buffer_load_dwordx4 v8, s[20:23], s69 offen offset:2048 sc1 lds
s_waitcnt lgkmcnt(10)
v_mfma_f32_16x16x32_bf16 v[184:187], a[80:83], v[88:91], v[184:187]
ds_read_b128 v[84:87], v55 offset:46080
v_mfma_f32_16x16x32_bf16 v[188:191], a[84:87], v[88:91], v[188:191]
v_mfma_f32_16x16x32_bf16 v[184:187], a[88:91], v[92:95], v[184:187]
ds_read_b128 v[88:91], v55 offset:47104
v_mfma_f32_16x16x32_bf16 v[188:191], a[92:95], v[92:95], v[188:191]
s_waitcnt lgkmcnt(8)
v_mfma_f32_16x16x32_bf16 v[192:195], a[64:67], v[64:67], v[192:195]
ds_read_b128 v[92:95], v55 offset:48128
v_mfma_f32_16x16x32_bf16 v[196:199], a[68:71], v[64:67], v[196:199]
s_waitcnt lgkmcnt(4)
s_waitcnt vmcnt(10)
s_barrier
v_mfma_f32_16x16x32_bf16 v[192:195], a[72:75], v[68:71], v[192:195]
ds_read_b128 v[64:67], v53 offset:0
v_mfma_f32_16x16x32_bf16 v[196:199], a[76:79], v[68:71], v[196:199]
s_add_u32 s30, s84, 131072
s_add_u32 m0, s32, 16384
s_nop 0
buffer_load_dwordx4 v148, s[40:43], s30 offen offset:0 lds
ds_read_b64_tr_b16 a[112:113], v18 offset:32768
v_mfma_f32_16x16x32_bf16 v[192:195], a[80:83], v[72:75], v[192:195]
ds_read_b128 v[68:71], v53 offset:1024
v_mfma_f32_16x16x32_bf16 v[196:199], a[84:87], v[72:75], v[196:199]
buffer_load_dwordx4 v149, s[40:43], s30 offen offset:1024 lds
ds_read_b64_tr_b16 a[114:115], v18 offset:36864
v_mfma_f32_16x16x32_bf16 v[192:195], a[88:91], v[76:79], v[192:195]
ds_read_b128 v[72:75], v53 offset:2048
v_mfma_f32_16x16x32_bf16 v[196:199], a[92:95], v[76:79], v[196:199]
buffer_load_dwordx4 v150, s[40:43], s30 offen offset:2048 lds
ds_read_b64_tr_b16 a[116:117], v19 offset:32768
s_waitcnt lgkmcnt(8)
v_mfma_f32_16x16x32_bf16 v[200:203], a[64:67], v[80:83], v[200:203]
ds_read_b128 v[76:79], v53 offset:3072
v_mfma_f32_16x16x32_bf16 v[204:207], a[68:71], v[80:83], v[204:207]
buffer_load_dwordx4 v151, s[40:43], s30 offen offset:3072 lds
ds_read_b64_tr_b16 a[118:119], v19 offset:36864
v_mfma_f32_16x16x32_bf16 v[200:203], a[72:75], v[84:87], v[200:203]
ds_read_b128 v[80:83], v53 offset:4096
v_mfma_f32_16x16x32_bf16 v[204:207], a[76:79], v[84:87], v[204:207]
s_bitcmp1_b32 s54, 14
s_cbranch_scc0 L_slow11
L_back11:
ds_read_b64_tr_b16 a[120:121], v18 offset:40960
s_waitcnt lgkmcnt(10)
v_mfma_f32_16x16x32_bf16 v[200:203], a[80:83], v[88:91], v[200:203]
ds_read_b128 v[84:87], v53 offset:5120
v_mfma_f32_16x16x32_bf16 v[204:207], a[84:87], v[88:91], v[204:207]
s_add_u32 m0, s71, 86016
ds_read_b64_tr_b16 a[122:123], v18 offset:45056
v_mfma_f32_16x16x32_bf16 v[200:203], a[88:91], v[92:95], v[200:203]
ds_read_b128 v[88:91], v53 offset:6144
v_mfma_f32_16x16x32_bf16 v[204:207], a[92:95], v[92:95], v[204:207]
buffer_load_dwordx4 v9, s[20:23], s69 offen offset:0 sc1 lds
ds_read_b64_tr_b16 a[124:125], v19 offset:40960
s_waitcnt lgkmcnt(11)
v_mfma_f32_16x16x32_bf16 v[160:163], a[96:99], v[64:67], v[160:163]
ds_read_b128 v[92:95], v53 offset:7168
v_mfma_f32_16x16x32_bf16 v[164:167], a[100:103], v[64:67], v[164:167]
buffer_load_dwordx4 v9, s[20:23], s69 offen offset:1024 sc1 lds
ds_read_b64_tr_b16 a[126:127], v19 offset:45056
v_mfma_f32_16x16x32_bf16 v[160:163], a[104:107], v[68:71], v[160:163]
ds_read_b128 v[64:67], v53 offset:8192
v_mfma_f32_16x16x32_bf16 v[164:167], a[108:111], v[68:71], v[164:167]
buffer_load_dwordx4 v9, s[20:23], s69 offen offset:2048 sc1 lds
s_waitcnt lgkmcnt(1)
v_mfma_f32_16x16x32_bf16 v[160:163], a[112:115], v[72:75], v[160:163]
ds_read_b128 v[68:71], v53 offset:9216
v_mfma_f32_16x16x32_bf16 v[164:167], a[116:119], v[72:75], v[164:167]
v_mfma_f32_16x16x32_bf16 v[160:163], a[120:123], v[76:79], v[160:163]
ds_read_b128 v[72:75], v53 offset:10240
v_mfma_f32_16x16x32_bf16 v[164:167], a[124:127], v[76:79], v[164:167]
v_mfma_f32_16x16x32_bf16 v[168:171], a[96:99], v[80:83], v[168:171]
ds_read_b128 v[76:79], v53 offset:11264
v_mfma_f32_16x16x32_bf16 v[172:175], a[100:103], v[80:83], v[172:175]
s_waitcnt vmcnt(10)
s_barrier
v_mfma_f32_16x16x32_bf16 v[168:171], a[104:107], v[84:87], v[168:171]
ds_read_b128 v[80:83], v53 offset:12288
v_mfma_f32_16x16x32_bf16 v[172:175], a[108:111], v[84:87], v[172:175]
s_add_u32 m0, s32, 32768
s_nop 0
buffer_load_dwordx4 v148, s[40:43], s85 offen offset:0 lds
ds_read_b64_tr_b16 a[128:129], v18 offset:0
v_mfma_f32_16x16x32_bf16 v[168:171], a[112:115], v[88:91], v[168:171]
ds_read_b128 v[84:87], v53 offset:13312
v_mfma_f32_16x16x32_bf16 v[172:175], a[116:119], v[88:91], v[172:175]
buffer_load_dwordx4 v149, s[40:43], s85 offen offset:1024 lds
ds_read_b64_tr_b16 a[130:131], v18 offset:4096
v_mfma_f32_16x16x32_bf16 v[168:171], a[120:123], v[92:95], v[168:171]
ds_read_b128 v[88:91], v53 offset:14336
v_mfma_f32_16x16x32_bf16 v[172:175], a[124:127], v[92:95], v[172:175]
buffer_load_dwordx4 v150, s[40:43], s85 offen offset:2048 lds
ds_read_b64_tr_b16 a[132:133], v19 offset:0
s_waitcnt lgkmcnt(8)
v_mfma_f32_16x16x32_bf16 v[176:179], a[96:99], v[64:67], v[176:179]
ds_read_b128 v[92:95], v53 offset:15360
v_mfma_f32_16x16x32_bf16 v[180:183], a[100:103], v[64:67], v[180:183]
buffer_load_dwordx4 v151, s[40:43], s85 offen offset:3072 lds
ds_read_b64_tr_b16 a[134:135], v19 offset:4096
v_mfma_f32_16x16x32_bf16 v[176:179], a[104:107], v[68:71], v[176:179]
ds_read_b128 v[64:67], v53 offset:16384
v_mfma_f32_16x16x32_bf16 v[180:183], a[108:111], v[68:71], v[180:183]
s_bitcmp1_b32 s54, 7
s_cbranch_scc0 L_slow12
L_back12:
ds_read_b64_tr_b16 a[136:137], v18 offset:8192
s_waitcnt lgkmcnt(10)
v_mfma_f32_16x16x32_bf16 v[176:179], a[112:115], v[72:75], v[176:179]
ds_read_b128 v[68:71], v53 offset:17408
v_mfma_f32_16x16x32_bf16 v[180:183], a[116:119], v[72:75], v[180:183]
s_add_u32 m0, s71, 106496
ds_read_b64_tr_b16 a[138:139], v18 offset:12288
v_mfma_f32_16x16x32_bf16 v[176:179], a[120:123], v[76:79], v[176:179]
ds_read_b128 v[72:75], v53 offset:18432
v_mfma_f32_16x16x32_bf16 v[180:183], a[124:127], v[76:79], v[180:183]
buffer_load_dwordx4 v8, s[20:23], s70 offen offset:0 sc1 lds
ds_read_b64_tr_b16 a[140:141], v19 offset:8192
s_waitcnt lgkmcnt(11)
v_mfma_f32_16x16x32_bf16 v[184:187], a[96:99], v[80:83], v[184:187]
ds_read_b128 v[76:79], v53 offset:19456
v_mfma_f32_16x16x32_bf16 v[188:191], a[100:103], v[80:83], v[188:191]
buffer_load_dwordx4 v8, s[20:23], s70 offen offset:1024 sc1 lds
ds_read_b64_tr_b16 a[142:143], v19 offset:12288
v_mfma_f32_16x16x32_bf16 v[184:187], a[104:107], v[84:87], v[184:187]
ds_read_b128 v[80:83], v53 offset:20480
v_mfma_f32_16x16x32_bf16 v[188:191], a[108:111], v[84:87], v[188:191]
buffer_load_dwordx4 v8, s[20:23], s70 offen offset:2048 sc1 lds
s_waitcnt lgkmcnt(10)
v_mfma_f32_16x16x32_bf16 v[184:187], a[112:115], v[88:91], v[184:187]
ds_read_b128 v[84:87], v53 offset:21504
v_mfma_f32_16x16x32_bf16 v[188:191], a[116:119], v[88:91], v[188:191]
v_mfma_f32_16x16x32_bf16 v[184:187], a[120:123], v[92:95], v[184:187]
ds_read_b128 v[88:91], v53 offset:22528
v_mfma_f32_16x16x32_bf16 v[188:191], a[124:127], v[92:95], v[188:191]
s_waitcnt lgkmcnt(8)
v_mfma_f32_16x16x32_bf16 v[192:195], a[96:99], v[64:67], v[192:195]
ds_read_b128 v[92:95], v53 offset:23552
v_mfma_f32_16x16x32_bf16 v[196:199], a[100:103], v[64:67], v[196:199]
s_waitcnt lgkmcnt(4)
s_waitcnt vmcnt(10)
s_barrier
v_mfma_f32_16x16x32_bf16 v[192:195], a[104:107], v[68:71], v[192:195]
ds_read_b128 v[64:67], v53 offset:24576
v_mfma_f32_16x16x32_bf16 v[196:199], a[108:111], v[68:71], v[196:199]
s_add_u32 s30, s85, 131072
s_add_u32 m0, s32, 0
s_nop 0
buffer_load_dwordx4 v148, s[40:43], s30 offen offset:0 lds
ds_read_b64_tr_b16 a[144:145], v18 offset:16384
v_mfma_f32_16x16x32_bf16 v[192:195], a[112:115], v[72:75], v[192:195]
ds_read_b128 v[68:71], v53 offset:25600
v_mfma_f32_16x16x32_bf16 v[196:199], a[116:119], v[72:75], v[196:199]
buffer_load_dwordx4 v149, s[40:43], s30 offen offset:1024 lds
ds_read_b64_tr_b16 a[146:147], v18 offset:20480
v_mfma_f32_16x16x32_bf16 v[192:195], a[120:123], v[76:79], v[192:195]
ds_read_b128 v[72:75], v53 offset:26624
v_mfma_f32_16x16x32_bf16 v[196:199], a[124:127], v[76:79], v[196:199]
buffer_load_dwordx4 v150, s[40:43], s30 offen offset:2048 lds
ds_read_b64_tr_b16 a[148:149], v19 offset:16384
s_waitcnt lgkmcnt(8)
v_mfma_f32_16x16x32_bf16 v[200:203], a[96:99], v[80:83], v[200:203]
ds_read_b128 v[76:79], v53 offset:27648
v_mfma_f32_16x16x32_bf16 v[204:207], a[100:103], v[80:83], v[204:207]
buffer_load_dwordx4 v151, s[40:43], s30 offen offset:3072 lds
ds_read_b64_tr_b16 a[150:151], v19 offset:20480
v_mfma_f32_16x16x32_bf16 v[200:203], a[104:107], v[84:87], v[200:203]
ds_read_b128 v[80:83], v53 offset:28672
v_mfma_f32_16x16x32_bf16 v[204:207], a[108:111], v[84:87], v[204:207]
s_bitcmp1_b32 s54, 15
s_cbranch_scc0 L_slow13
L_back13:
ds_read_b64_tr_b16 a[152:153], v18 offset:24576
s_waitcnt lgkmcnt(10)
v_mfma_f32_16x16x32_bf16 v[200:203], a[112:115], v[88:91], v[200:203]
ds_read_b128 v[84:87], v53 offset:29696
v_mfma_f32_16x16x32_bf16 v[204:207], a[116:119], v[88:91], v[204:207]
s_add_u32 m0, s71, 118784
ds_read_b64_tr_b16 a[154:155], v18 offset:28672
v_mfma_f32_16x16x32_bf16 v[200:203], a[120:123], v[92:95], v[200:203]
ds_read_b128 v[88:91], v53 offset:30720
v_mfma_f32_16x16x32_bf16 v[204:207], a[124:127], v[92:95], v[204:207]
buffer_load_dwordx4 v9, s[20:23], s70 offen offset:0 sc1 lds
ds_read_b64_tr_b16 a[156:157], v19 offset:24576
s_waitcnt lgkmcnt(11)
v_mfma_f32_16x16x32_bf16 v[160:163], a[128:131], v[64:67], v[160:163]
ds_read_b128 v[92:95], v53 offset:31744
v_mfma_f32_16x16x32_bf16 v[164:167], a[132:135], v[64:67], v[164:167]
buffer_load_dwordx4 v9, s[20:23], s70 offen offset:1024 sc1 lds
ds_read_b64_tr_b16 a[158:159], v19 offset:28672
v_mfma_f32_16x16x32_bf16 v[160:163], a[136:139], v[68:71], v[160:163]
ds_read_b128 v[64:67], v53 offset:32768
v_mfma_f32_16x16x32_bf16 v[164:167], a[140:143], v[68:71], v[164:167]
buffer_load_dwordx4 v9, s[20:23], s70 offen offset:2048 sc1 lds
s_waitcnt lgkmcnt(1)
v_mfma_f32_16x16x32_bf16 v[160:163], a[144:147], v[72:75], v[160:163]
ds_read_b128 v[68:71], v53 offset:33792
v_mfma_f32_16x16x32_bf16 v[164:167], a[148:151], v[72:75], v[164:167]
v_mfma_f32_16x16x32_bf16 v[160:163], a[152:155], v[76:79], v[160:163]
ds_read_b128 v[72:75], v53 offset:34816
v_mfma_f32_16x16x32_bf16 v[164:167], a[156:159], v[76:79], v[164:167]
v_mfma_f32_16x16x32_bf16 v[168:171], a[128:131], v[80:83], v[168:171]
ds_read_b128 v[76:79], v53 offset:35840
v_mfma_f32_16x16x32_bf16 v[172:175], a[132:135], v[80:83], v[172:175]
s_waitcnt vmcnt(10)
s_barrier
v_mfma_f32_16x16x32_bf16 v[168:171], a[136:139], v[84:87], v[168:171]
ds_read_b128 v[80:83], v53 offset:36864
v_mfma_f32_16x16x32_bf16 v[172:175], a[140:143], v[84:87], v[172:175]
s_and_b32 s3, s54, 0xfe0000
s_cmp_eq_u32 s3, 0xfe0000
s_cbranch_scc0 L_slow14
L_back14:
ds_read_b64_tr_b16 a[160:161], v18 offset:32768
v_mfma_f32_16x16x32_bf16 v[168:171], a[144:147], v[88:91], v[168:171]
ds_read_b128 v[84:87], v53 offset:37888
v_mfma_f32_16x16x32_bf16 v[172:175], a[148:151], v[88:91], v[172:175]
ds_read_b64_tr_b16 a[162:163], v18 offset:36864
v_mfma_f32_16x16x32_bf16 v[168:171], a[152:155], v[92:95], v[168:171]
ds_read_b128 v[88:91], v53 offset:38912
v_mfma_f32_16x16x32_bf16 v[172:175], a[156:159], v[92:95], v[172:175]
s_add_u32 m0, s71, 131072
ds_read_b64_tr_b16 a[164:165], v19 offset:32768
s_waitcnt lgkmcnt(8)
v_mfma_f32_16x16x32_bf16 v[176:179], a[128:131], v[64:67], v[176:179]
ds_read_b128 v[92:95], v53 offset:39936
v_mfma_f32_16x16x32_bf16 v[180:183], a[132:135], v[64:67], v[180:183]
ds_read_b64_tr_b16 a[166:167], v19 offset:36864
v_mfma_f32_16x16x32_bf16 v[176:179], a[136:139], v[68:71], v[176:179]
ds_read_b128 v[64:67], v53 offset:40960
v_mfma_f32_16x16x32_bf16 v[180:183], a[140:143], v[68:71], v[180:183]
buffer_load_dwordx4 v10, s[20:23], s64 offen offset:0 sc1 lds
ds_read_b64_tr_b16 a[168:169], v18 offset:40960
s_waitcnt lgkmcnt(10)
v_mfma_f32_16x16x32_bf16 v[176:179], a[144:147], v[72:75], v[176:179]
ds_read_b128 v[68:71], v53 offset:41984
v_mfma_f32_16x16x32_bf16 v[180:183], a[148:151], v[72:75], v[180:183]
ds_read_b64_tr_b16 a[170:171], v18 offset:45056
v_mfma_f32_16x16x32_bf16 v[176:179], a[152:155], v[76:79], v[176:179]
ds_read_b128 v[72:75], v53 offset:43008
v_mfma_f32_16x16x32_bf16 v[180:183], a[156:159], v[76:79], v[180:183]
buffer_load_dwordx4 v10, s[20:23], s64 offen offset:1024 sc1 lds
ds_read_b64_tr_b16 a[172:173], v19 offset:40960
s_waitcnt lgkmcnt(11)
v_mfma_f32_16x16x32_bf16 v[184:187], a[128:131], v[80:83], v[184:187]
ds_read_b128 v[76:79], v53 offset:44032
v_mfma_f32_16x16x32_bf16 v[188:191], a[132:135], v[80:83], v[188:191]
ds_read_b64_tr_b16 a[174:175], v19 offset:45056
v_mfma_f32_16x16x32_bf16 v[184:187], a[136:139], v[84:87], v[184:187]
ds_read_b128 v[80:83], v53 offset:45056
v_mfma_f32_16x16x32_bf16 v[188:191], a[140:143], v[84:87], v[188:191]
buffer_load_dwordx4 v10, s[20:23], s64 offen offset:2048 sc1 lds
s_waitcnt lgkmcnt(10)
v_mfma_f32_16x16x32_bf16 v[184:187], a[144:147], v[88:91], v[184:187]
ds_read_b128 v[84:87], v53 offset:46080
v_mfma_f32_16x16x32_bf16 v[188:191], a[148:151], v[88:91], v[188:191]
v_mfma_f32_16x16x32_bf16 v[184:187], a[152:155], v[92:95], v[184:187]
ds_read_b128 v[88:91], v53 offset:47104
v_mfma_f32_16x16x32_bf16 v[188:191], a[156:159], v[92:95], v[188:191]
s_waitcnt lgkmcnt(8)
v_mfma_f32_16x16x32_bf16 v[192:195], a[128:131], v[64:67], v[192:195]
ds_read_b128 v[92:95], v53 offset:48128
v_mfma_f32_16x16x32_bf16 v[196:199], a[132:135], v[64:67], v[196:199]
s_waitcnt lgkmcnt(4)
s_waitcnt vmcnt(6)
s_barrier
v_mfma_f32_16x16x32_bf16 v[192:195], a[136:139], v[68:71], v[192:195]
ds_read_b128 v[64:67], v55 offset:0
v_mfma_f32_16x16x32_bf16 v[196:199], a[140:143], v[68:71], v[196:199]
s_add_u32 m0, s71, 143360
ds_read_b64_tr_b16 a[176:177], v18 offset:0
v_mfma_f32_16x16x32_bf16 v[192:195], a[144:147], v[72:75], v[192:195]
ds_read_b128 v[68:71], v55 offset:1024
v_mfma_f32_16x16x32_bf16 v[196:199], a[148:151], v[72:75], v[196:199]
ds_read_b64_tr_b16 a[178:179], v18 offset:4096
v_mfma_f32_16x16x32_bf16 v[192:195], a[152:155], v[76:79], v[192:195]
ds_read_b128 v[72:75], v55 offset:2048
v_mfma_f32_16x16x32_bf16 v[196:199], a[156:159], v[76:79], v[196:199]
buffer_load_dwordx4 v10, s[20:23], s65 offen offset:0 sc1 lds
ds_read_b64_tr_b16 a[180:181], v19 offset:0
s_waitcnt lgkmcnt(8)
v_mfma_f32_16x16x32_bf16 v[200:203], a[128:131], v[80:83], v[200:203]
ds_read_b128 v[76:79], v55 offset:3072
v_mfma_f32_16x16x32_bf16 v[204:207], a[132:135], v[80:83], v[204:207]
ds_read_b64_tr_b16 a[182:183], v19 offset:4096
v_mfma_f32_16x16x32_bf16 v[200:203], a[136:139], v[84:87], v[200:203]
ds_read_b128 v[80:83], v55 offset:4096
v_mfma_f32_16x16x32_bf16 v[204:207], a[140:143], v[84:87], v[204:207]
ds_read_b64_tr_b16 a[184:185], v18 offset:8192
s_waitcnt lgkmcnt(10)
v_mfma_f32_16x16x32_bf16 v[200:203], a[144:147], v[88:91], v[200:203]
ds_read_b128 v[84:87], v55 offset:5120
v_mfma_f32_16x16x32_bf16 v[204:207], a[148:151], v[88:91], v[204:207]
buffer_load_dwordx4 v10, s[20:23], s65 offen offset:1024 sc1 lds
ds_read_b64_tr_b16 a[186:187], v18 offset:12288
v_mfma_f32_16x16x32_bf16 v[200:203], a[152:155], v[92:95], v[200:203]
ds_read_b128 v[88:91], v55 offset:6144
v_mfma_f32_16x16x32_bf16 v[204:207], a[156:159], v[92:95], v[204:207]
ds_read_b64_tr_b16 a[188:189], v19 offset:8192
s_waitcnt lgkmcnt(11)
v_mfma_f32_16x16x32_bf16 v[160:163], a[160:163], v[64:67], v[160:163]
ds_read_b128 v[92:95], v55 offset:7168
v_mfma_f32_16x16x32_bf16 v[164:167], a[164:167], v[64:67], v[164:167]
buffer_load_dwordx4 v10, s[20:23], s65 offen offset:2048 sc1 lds
ds_read_b64_tr_b16 a[190:191], v19 offset:12288
v_mfma_f32_16x16x32_bf16 v[160:163], a[168:171], v[68:71], v[160:163]
ds_read_b128 v[64:67], v55 offset:8192
v_mfma_f32_16x16x32_bf16 v[164:167], a[172:175], v[68:71], v[164:167]
s_waitcnt lgkmcnt(1)
v_mfma_f32_16x16x32_bf16 v[160:163], a[176:179], v[72:75], v[160:163]
ds_read_b128 v[68:71], v55 offset:9216
v_mfma_f32_16x16x32_bf16 v[164:167], a[180:183], v[72:75], v[164:167]
v_mfma_f32_16x16x32_bf16 v[160:163], a[184:187], v[76:79], v[160:163]
ds_read_b128 v[72:75], v55 offset:10240
v_mfma_f32_16x16x32_bf16 v[164:167], a[188:191], v[76:79], v[164:167]
v_mfma_f32_16x16x32_bf16 v[168:171], a[160:163], v[80:83], v[168:171]
ds_read_b128 v[76:79], v55 offset:11264
v_mfma_f32_16x16x32_bf16 v[172:175], a[164:167], v[80:83], v[172:175]
s_waitcnt vmcnt(3)
s_barrier
v_mfma_f32_16x16x32_bf16 v[168:171], a[168:171], v[84:87], v[168:171]
ds_read_b128 v[80:83], v55 offset:12288
v_mfma_f32_16x16x32_bf16 v[172:175], a[172:175], v[84:87], v[172:175]
s_add_u32 m0, s71, 49152
v_mfma_f32_16x16x32_bf16 v[168:171], a[176:179], v[88:91], v[168:171]
ds_read_b128 v[84:87], v55 offset:13312
v_mfma_f32_16x16x32_bf16 v[172:175], a[180:183], v[88:91], v[172:175]
buffer_load_dwordx4 v10, s[20:23], s66 offen offset:0 sc1 lds
v_mfma_f32_16x16x32_bf16 v[168:171], a[184:187], v[92:95], v[168:171]
ds_read_b128 v[88:91], v55 offset:14336
v_mfma_f32_16x16x32_bf16 v[172:175], a[188:191], v[92:95], v[172:175]
s_waitcnt lgkmcnt(5)
v_mfma_f32_16x16x32_bf16 v[176:179], a[160:163], v[64:67], v[176:179]
ds_read_b128 v[92:95], v55 offset:15360
v_mfma_f32_16x16x32_bf16 v[180:183], a[164:167], v[64:67], v[180:183]
buffer_load_dwordx4 v10, s[20:23], s66 offen offset:1024 sc1 lds
v_mfma_f32_16x16x32_bf16 v[176:179], a[168:171], v[68:71], v[176:179]
ds_read_b128 v[64:67], v55 offset:16384
v_mfma_f32_16x16x32_bf16 v[180:183], a[172:175], v[68:71], v[180:183]
s_waitcnt lgkmcnt(5)
v_mfma_f32_16x16x32_bf16 v[176:179], a[176:179], v[72:75], v[176:179]
ds_read_b128 v[68:71], v55 offset:17408
v_mfma_f32_16x16x32_bf16 v[180:183], a[180:183], v[72:75], v[180:183]
buffer_load_dwordx4 v10, s[20:23], s66 offen offset:2048 sc1 lds
v_mfma_f32_16x16x32_bf16 v[176:179], a[184:187], v[76:79], v[176:179]
ds_read_b128 v[72:75], v55 offset:18432
v_mfma_f32_16x16x32_bf16 v[180:183], a[188:191], v[76:79], v[180:183]
s_waitcnt lgkmcnt(5)
v_mfma_f32_16x16x32_bf16 v[184:187], a[160:163], v[80:83], v[184:187]
ds_read_b128 v[76:79], v55 offset:19456
v_mfma_f32_16x16x32_bf16 v[188:191], a[164:167], v[80:83], v[188:191]
s_add_u32 m0, s71, 61440
v_mfma_f32_16x16x32_bf16 v[184:187], a[168:171], v[84:87], v[184:187]
ds_read_b128 v[80:83], v55 offset:20480
v_mfma_f32_16x16x32_bf16 v[188:191], a[172:175], v[84:87], v[188:191]
s_waitcnt lgkmcnt(5)
v_mfma_f32_16x16x32_bf16 v[184:187], a[176:179], v[88:91], v[184:187]
ds_read_b128 v[84:87], v55 offset:21504
v_mfma_f32_16x16x32_bf16 v[188:191], a[180:183], v[88:91], v[188:191]
buffer_load_dwordx4 v10, s[20:23], s67 offen offset:0 sc1 lds
v_mfma_f32_16x16x32_bf16 v[184:187], a[184:187], v[92:95], v[184:187]
ds_read_b128 v[88:91], v55 offset:22528
v_mfma_f32_16x16x32_bf16 v[188:191], a[188:191], v[92:95], v[188:191]
s_waitcnt lgkmcnt(5)
v_mfma_f32_16x16x32_bf16 v[192:195], a[160:163], v[64:67], v[192:195]
ds_read_b128 v[92:95], v55 offset:23552
v_mfma_f32_16x16x32_bf16 v[196:199], a[164:167], v[64:67], v[196:199]
buffer_load_dwordx4 v10, s[20:23], s67 offen offset:1024 sc1 lds
v_cvt_pk_bf16_f32 v136, v160, v161
v_cvt_pk_bf16_f32 v137, v162, v163
v_mfma_f32_16x16x32_bf16 v[192:195], a[168:171], v[68:71], v[192:195]
ds_read_b128 v[64:67], v55 offset:24576
v_mfma_f32_16x16x32_bf16 v[196:199], a[172:175], v[68:71], v[196:199]
buffer_load_dwordx4 v10, s[20:23], s67 offen offset:2048 sc1 lds
v_cvt_pk_bf16_f32 v138, v164, v165
s_waitcnt lgkmcnt(5)
v_mfma_f32_16x16x32_bf16 v[192:195], a[176:179], v[72:75], v[192:195]
ds_read_b128 v[68:71], v55 offset:25600
v_mfma_f32_16x16x32_bf16 v[196:199], a[180:183], v[72:75], v[196:199]
v_cvt_pk_bf16_f32 v139, v166, v167
s_add_u32 s35, s72, 0
buffer_store_dwordx4 v[136:139], v52, s[20:23], s35 offen sc1
v_mfma_f32_16x16x32_bf16 v[192:195], a[184:187], v[76:79], v[192:195]
ds_read_b128 v[72:75], v55 offset:26624
v_mfma_f32_16x16x32_bf16 v[196:199], a[188:191], v[76:79], v[196:199]
s_add_u32 m0, s71, 73728
v_cvt_pk_bf16_f32 v140, v168, v169
s_waitcnt lgkmcnt(5)
v_mfma_f32_16x16x32_bf16 v[200:203], a[160:163], v[80:83], v[200:203]
ds_read_b128 v[76:79], v55 offset:27648
v_mfma_f32_16x16x32_bf16 v[204:207], a[164:167], v[80:83], v[204:207]
v_cvt_pk_bf16_f32 v141, v170, v171
v_cvt_pk_bf16_f32 v142, v172, v173
v_mfma_f32_16x16x32_bf16 v[200:203], a[168:171], v[84:87], v[200:203]
ds_read_b128 v[80:83], v55 offset:28672
v_mfma_f32_16x16x32_bf16 v[204:207], a[172:175], v[84:87], v[204:207]
buffer_load_dwordx4 v10, s[20:23], s68 offen offset:0 sc1 lds
v_cvt_pk_bf16_f32 v143, v174, v175
s_waitcnt lgkmcnt(5)
v_mfma_f32_16x16x32_bf16 v[200:203], a[176:179], v[88:91], v[200:203]
ds_read_b128 v[84:87], v55 offset:29696
v_mfma_f32_16x16x32_bf16 v[204:207], a[180:183], v[88:91], v[204:207]
s_add_u32 s35, s72, 4096
buffer_store_dwordx4 v[140:143], v52, s[20:23], s35 offen sc1
v_cvt_pk_bf16_f32 v136, v176, v177
v_mfma_f32_16x16x32_bf16 v[200:203], a[184:187], v[92:95], v[200:203]
ds_read_b128 v[88:91], v55 offset:30720
v_mfma_f32_16x16x32_bf16 v[204:207], a[188:191], v[92:95], v[204:207]
buffer_load_dwordx4 v10, s[20:23], s68 offen offset:1024 sc1 lds
v_cvt_pk_bf16_f32 v137, v178, v179
s_waitcnt lgkmcnt(5)
v_mfma_f32_16x16x32_bf16 v[208:211], a[224:227], v[64:67], v[208:211]
ds_read_b128 v[92:95], v55 offset:31744
v_mfma_f32_16x16x32_bf16 v[212:215], a[228:231], v[64:67], v[212:215]
v_cvt_pk_bf16_f32 v138, v180, v181
v_cvt_pk_bf16_f32 v139, v182, v183
v_mfma_f32_16x16x32_bf16 v[208:211], a[232:235], v[68:71], v[208:211]
ds_read_b128 v[64:67], v55 offset:32768
v_mfma_f32_16x16x32_bf16 v[212:215], a[236:239], v[68:71], v[212:215]
buffer_load_dwordx4 v10, s[20:23], s68 offen offset:2048 sc1 lds
s_waitcnt lgkmcnt(5)
v_mfma_f32_16x16x32_bf16 v[208:211], a[240:243], v[72:75], v[208:211]
ds_read_b128 v[68:71], v55 offset:33792
v_mfma_f32_16x16x32_bf16 v[212:215], a[244:247], v[72:75], v[212:215]
s_add_u32 s35, s72, 8192
buffer_store_dwordx4 v[136:139], v52, s[20:23], s35 offen sc1
v_mfma_f32_16x16x32_bf16 v[208:211], a[248:251], v[76:79], v[208:211]
ds_read_b128 v[72:75], v55 offset:34816
v_mfma_f32_16x16x32_bf16 v[212:215], a[252:255], v[76:79], v[212:215]
s_waitcnt lgkmcnt(5)
v_mfma_f32_16x16x32_bf16 v[216:219], a[224:227], v[80:83], v[216:219]
ds_read_b128 v[76:79], v55 offset:35840
v_mfma_f32_16x16x32_bf16 v[220:223], a[228:231], v[80:83], v[220:223]
s_waitcnt vmcnt(9)
s_barrier
v_cvt_pk_bf16_f32 v140, v184, v185
v_cvt_pk_bf16_f32 v141, v186, v187
v_mfma_f32_16x16x32_bf16 v[216:219], a[232:235], v[84:87], v[216:219]
ds_read_b128 v[80:83], v55 offset:36864
v_mfma_f32_16x16x32_bf16 v[220:223], a[236:239], v[84:87], v[220:223]
s_add_u32 m0, s71, 86016
v_cvt_pk_bf16_f32 v142, v188, v189
s_waitcnt lgkmcnt(5)
v_mfma_f32_16x16x32_bf16 v[216:219], a[240:243], v[88:91], v[216:219]
ds_read_b128 v[84:87], v55 offset:37888
v_mfma_f32_16x16x32_bf16 v[220:223], a[244:247], v[88:91], v[220:223]
v_cvt_pk_bf16_f32 v143, v190, v191
s_add_u32 s35, s73, 12288
buffer_store_dwordx4 v[140:143], v52, s[20:23], s35 offen sc1
v_mfma_f32_16x16x32_bf16 v[216:219], a[248:251], v[92:95], v[216:219]
ds_read_b128 v[88:91], v55 offset:38912
v_mfma_f32_16x16x32_bf16 v[220:223], a[252:255], v[92:95], v[220:223]
buffer_load_dwordx4 v10, s[20:23], s69 offen offset:0 sc1 lds
v_cvt_pk_bf16_f32 v136, v192, v193
s_waitcnt lgkmcnt(5)
v_mfma_f32_16x16x32_bf16 v[224:227], a[224:227], v[64:67], v[224:227]
ds_read_b128 v[92:95], v55 offset:39936
v_mfma_f32_16x16x32_bf16 v[228:231], a[228:231], v[64:67], v[228:231]
v_cvt_pk_bf16_f32 v137, v194, v195
v_cvt_pk_bf16_f32 v138, v196, v197
v_mfma_f32_16x16x32_bf16 v[224:227], a[232:235], v[68:71], v[224:227]
ds_read_b128 v[64:67], v55 offset:40960
v_mfma_f32_16x16x32_bf16 v[228:231], a[236:239], v[68:71], v[228:231]
v_cvt_pk_bf16_f32 v139, v198, v199
s_waitcnt lgkmcnt(5)
v_mfma_f32_16x16x32_bf16 v[224:227], a[240:243], v[72:75], v[224:227]
ds_read_b128 v[68:71], v55 offset:41984
v_mfma_f32_16x16x32_bf16 v[228:231], a[244:247], v[72:75], v[228:231]
buffer_load_dwordx4 v10, s[20:23], s69 offen offset:1024 sc1 lds
v_mfma_f32_16x16x32_bf16 v[224:227], a[248:251], v[76:79], v[224:227]
ds_read_b128 v[72:75], v55 offset:43008
v_mfma_f32_16x16x32_bf16 v[228:231], a[252:255], v[76:79], v[228:231]
s_add_u32 s35, s73, 16384
buffer_store_dwordx4 v[136:139], v52, s[20:23], s35 offen sc1
v_cvt_pk_bf16_f32 v140, v200, v201
v_cvt_pk_bf16_f32 v141, v202, v203
s_waitcnt lgkmcnt(5)
v_mfma_f32_16x16x32_bf16 v[208:211], a[0:3], v[80:83], v[208:211]
ds_read_b128 v[76:79], v55 offset:44032
v_mfma_f32_16x16x32_bf16 v[212:215], a[4:7], v[80:83], v[212:215]
v_cvt_pk_bf16_f32 v142, v204, v205
v_cvt_pk_bf16_f32 v143, v206, v207
v_mfma_f32_16x16x32_bf16 v[208:211], a[8:11], v[84:87], v[208:211]
ds_read_b128 v[80:83], v55 offset:45056
v_mfma_f32_16x16x32_bf16 v[212:215], a[12:15], v[84:87], v[212:215]
buffer_load_dwordx4 v10, s[20:23], s69 offen offset:2048 sc1 lds
s_waitcnt lgkmcnt(5)
v_mfma_f32_16x16x32_bf16 v[208:211], a[16:19], v[88:91], v[208:211]
ds_read_b128 v[84:87], v55 offset:46080
v_mfma_f32_16x16x32_bf16 v[212:215], a[20:23], v[88:91], v[212:215]
s_add_u32 s35, s73, 20480
buffer_store_dwordx4 v[140:143], v52, s[20:23], s35 offen sc1
v_mfma_f32_16x16x32_bf16 v[208:211], a[24:27], v[92:95], v[208:211]
ds_read_b128 v[88:91], v55 offset:47104
v_mfma_f32_16x16x32_bf16 v[212:215], a[28:31], v[92:95], v[212:215]
s_waitcnt lgkmcnt(5)
v_mfma_f32_16x16x32_bf16 v[216:219], a[0:3], v[64:67], v[216:219]
ds_read_b128 v[92:95], v55 offset:48128
v_mfma_f32_16x16x32_bf16 v[220:223], a[4:7], v[64:67], v[220:223]
s_add_u32 m0, s71, 106496
v_mfma_f32_16x16x32_bf16 v[216:219], a[8:11], v[68:71], v[216:219]
ds_read_b128 v[64:67], v53 offset:0
v_mfma_f32_16x16x32_bf16 v[220:223], a[12:15], v[68:71], v[220:223]
s_waitcnt lgkmcnt(5)
v_mfma_f32_16x16x32_bf16 v[216:219], a[16:19], v[72:75], v[216:219]
ds_read_b128 v[68:71], v53 offset:1024
v_mfma_f32_16x16x32_bf16 v[220:223], a[20:23], v[72:75], v[220:223]
buffer_load_dwordx4 v10, s[20:23], s70 offen offset:0 sc1 lds
v_mfma_f32_16x16x32_bf16 v[216:219], a[24:27], v[76:79], v[216:219]
ds_read_b128 v[72:75], v53 offset:2048
v_mfma_f32_16x16x32_bf16 v[220:223], a[28:31], v[76:79], v[220:223]
s_waitcnt vmcnt(7)
s_mov_b64 exec, 1
v_mov_b32 v62, 0
buffer_store_dwordx2 v[60:61], v62, s[20:23], s75 offen sc1
s_mov_b64 exec, -1
s_waitcnt lgkmcnt(5)
v_mfma_f32_16x16x32_bf16 v[224:227], a[0:3], v[80:83], v[224:227]
ds_read_b128 v[76:79], v53 offset:3072
v_mfma_f32_16x16x32_bf16 v[228:231], a[4:7], v[80:83], v[228:231]
v_mfma_f32_16x16x32_bf16 v[224:227], a[8:11], v[84:87], v[224:227]
ds_read_b128 v[80:83], v53 offset:4096
v_mfma_f32_16x16x32_bf16 v[228:231], a[12:15], v[84:87], v[228:231]
buffer_load_dwordx4 v10, s[20:23], s70 offen offset:1024 sc1 lds
s_waitcnt lgkmcnt(5)
v_mfma_f32_16x16x32_bf16 v[224:227], a[16:19], v[88:91], v[224:227]
ds_read_b128 v[84:87], v53 offset:5120
v_mfma_f32_16x16x32_bf16 v[228:231], a[20:23], v[88:91], v[228:231]
v_mfma_f32_16x16x32_bf16 v[224:227], a[24:27], v[92:95], v[224:227]
ds_read_b128 v[88:91], v53 offset:6144
v_mfma_f32_16x16x32_bf16 v[228:231], a[28:31], v[92:95], v[228:231]
s_waitcnt lgkmcnt(5)
v_mfma_f32_16x16x32_bf16 v[208:211], a[32:35], v[64:67], v[208:211]
ds_read_b128 v[92:95], v53 offset:7168
v_mfma_f32_16x16x32_bf16 v[212:215], a[36:39], v[64:67], v[212:215]
buffer_load_dwordx4 v10, s[20:23], s70 offen offset:2048 sc1 lds
v_mov_b32 v144, 0
v_mfma_f32_16x16x32_bf16 v[208:211], a[40:43], v[68:71], v[208:211]
ds_read_b128 v[64:67], v53 offset:8192
v_mfma_f32_16x16x32_bf16 v[212:215], a[44:47], v[68:71], v[212:215]
v_mov_b32 v145, 0
s_waitcnt lgkmcnt(5)
v_mfma_f32_16x16x32_bf16 v[208:211], a[48:51], v[72:75], v[208:211]
ds_read_b128 v[68:71], v53 offset:9216
v_mfma_f32_16x16x32_bf16 v[212:215], a[52:55], v[72:75], v[212:215]
v_mov_b32 v148, 0
v_mfma_f32_16x16x32_bf16 v[208:211], a[56:59], v[76:79], v[208:211]
ds_read_b128 v[72:75], v53 offset:10240
v_mfma_f32_16x16x32_bf16 v[212:215], a[60:63], v[76:79], v[212:215]
v_mov_b32 v149, 0
s_waitcnt lgkmcnt(5)
v_mfma_f32_16x16x32_bf16 v[216:219], a[32:35], v[80:83], v[216:219]
ds_read_b128 v[76:79], v53 offset:11264
v_mfma_f32_16x16x32_bf16 v[220:223], a[36:39], v[80:83], v[220:223]
s_barrier
v_and_b32 v5, 1, v1
v_mfma_f32_16x16x32_bf16 v[216:219], a[40:43], v[84:87], v[216:219]
ds_read_b128 v[80:83], v53 offset:12288
v_mfma_f32_16x16x32_bf16 v[220:223], a[44:47], v[84:87], v[220:223]
s_and_b32 s3, s54, 0xfe000000
s_cmp_eq_u32 s3, 0xfe000000
s_cbranch_scc0 L_slow15
L_back15:
v_lshlrev_b32 v5, 4, v5
s_waitcnt lgkmcnt(5)
v_mfma_f32_16x16x32_bf16 v[216:219], a[48:51], v[88:91], v[216:219]
ds_read_b128 v[84:87], v53 offset:13312
v_mfma_f32_16x16x32_bf16 v[220:223], a[52:55], v[88:91], v[220:223]
v_mov_b32 v6, 0x3f80
v_mfma_f32_16x16x32_bf16 v[216:219], a[56:59], v[92:95], v[216:219]
ds_read_b128 v[88:91], v53 offset:14336
v_mfma_f32_16x16x32_bf16 v[220:223], a[60:63], v[92:95], v[220:223]
s_waitcnt vmcnt(4)
s_mov_b64 exec, 1
v_mov_b32 v62, 0
buffer_store_dwordx2 v[60:61], v62, s[20:23], s76 offen sc1
s_mov_b64 exec, -1
s_add_u32 m0, s71, 118784
v_lshlrev_b32 v6, v5, v6
s_waitcnt lgkmcnt(5)
v_mfma_f32_16x16x32_bf16 v[224:227], a[32:35], v[64:67], v[224:227]
ds_read_b128 v[92:95], v53 offset:15360
v_mfma_f32_16x16x32_bf16 v[228:231], a[36:39], v[64:67], v[228:231]
v_lshrrev_b32 v7, 2, v4
v_mfma_f32_16x16x32_bf16 v[224:227], a[40:43], v[68:71], v[224:227]
ds_read_b128 v[64:67], v53 offset:16384
v_mfma_f32_16x16x32_bf16 v[228:231], a[44:47], v[68:71], v[228:231]
buffer_load_dwordx4 v11, s[20:23], s64 offen offset:0 sc1 lds
v_cmp_eq_u32 vcc, v7, v3
s_nop 1
v_cndmask_b32 v6, 0, v6, vcc
s_waitcnt lgkmcnt(5)
v_mfma_f32_16x16x32_bf16 v[224:227], a[48:51], v[72:75], v[224:227]
ds_read_b128 v[68:71], v53 offset:17408
v_mfma_f32_16x16x32_bf16 v[228:231], a[52:55], v[72:75], v[228:231]
v_and_b32 v7, 2, v1
v_mfma_f32_16x16x32_bf16 v[224:227], a[56:59], v[76:79], v[224:227]
ds_read_b128 v[72:75], v53 offset:18432
v_mfma_f32_16x16x32_bf16 v[228:231], a[60:63], v[76:79], v[228:231]
v_cmp_eq_u32 vcc, 0, v7
s_nop 1
v_cndmask_b32 v146, 0, v6, vcc
s_waitcnt lgkmcnt(5)
v_mfma_f32_16x16x32_bf16 v[208:211], a[64:67], v[80:83], v[208:211]
ds_read_b128 v[76:79], v53 offset:19456
v_mfma_f32_16x16x32_bf16 v[212:215], a[68:71], v[80:83], v[212:215]
buffer_load_dwordx4 v11, s[20:23], s64 offen offset:1024 sc1 lds
v_sub_u32 v147, v6, v146
v_mfma_f32_16x16x32_bf16 v[208:211], a[72:75], v[84:87], v[208:211]
ds_read_b128 v[80:83], v53 offset:20480
v_mfma_f32_16x16x32_bf16 v[212:215], a[76:79], v[84:87], v[212:215]
s_waitcnt lgkmcnt(5)
v_mfma_f32_16x16x32_bf16 v[208:211], a[80:83], v[88:91], v[208:211]
ds_read_b128 v[84:87], v53 offset:21504
v_mfma_f32_16x16x32_bf16 v[212:215], a[84:87], v[88:91], v[212:215]
buffer_load_dwordx4 v11, s[20:23], s64 offen offset:2048 sc1 lds
v_mfma_f32_16x16x32_bf16 v[208:211], a[88:91], v[92:95], v[208:211]
ds_read_b128 v[88:91], v53 offset:22528
v_mfma_f32_16x16x32_bf16 v[212:215], a[92:95], v[92:95], v[212:215]
s_waitcnt lgkmcnt(5)
v_mfma_f32_16x16x32_bf16 v[216:219], a[64:67], v[64:67], v[216:219]
ds_read_b128 v[92:95], v53 offset:23552
v_mfma_f32_16x16x32_bf16 v[220:223], a[68:71], v[64:67], v[220:223]
v_mfma_f32_16x16x32_bf16 v[216:219], a[72:75], v[68:71], v[216:219]
ds_read_b128 v[64:67], v53 offset:24576
v_mfma_f32_16x16x32_bf16 v[220:223], a[76:79], v[68:71], v[220:223]
s_add_u32 m0, s71, 131072
s_waitcnt lgkmcnt(5)
v_mfma_f32_16x16x32_bf16 v[216:219], a[80:83], v[72:75], v[216:219]
ds_read_b128 v[68:71], v53 offset:25600
v_mfma_f32_16x16x32_bf16 v[220:223], a[84:87], v[72:75], v[220:223]
v_mfma_f32_16x16x32_bf16 v[216:219], a[88:91], v[76:79], v[216:219]
ds_read_b128 v[72:75], v53 offset:26624
v_mfma_f32_16x16x32_bf16 v[220:223], a[92:95], v[76:79], v[220:223]
buffer_load_dwordx4 v11, s[20:23], s65 offen offset:0 sc1 lds
s_waitcnt lgkmcnt(5)
v_mfma_f32_16x16x32_bf16 v[224:227], a[64:67], v[80:83], v[224:227]
ds_read_b128 v[76:79], v53 offset:27648
v_mfma_f32_16x16x32_bf16 v[228:231], a[68:71], v[80:83], v[228:231]
v_mfma_f32_16x16x32_bf16 v[224:227], a[72:75], v[84:87], v[224:227]
ds_read_b128 v[80:83], v53 offset:28672
v_mfma_f32_16x16x32_bf16 v[228:231], a[76:79], v[84:87], v[228:231]
s_waitcnt lgkmcnt(5)
v_mfma_f32_16x16x32_bf16 v[224:227], a[80:83], v[88:91], v[224:227]
ds_read_b128 v[84:87], v53 offset:29696
v_mfma_f32_16x16x32_bf16 v[228:231], a[84:87], v[88:91], v[228:231]
buffer_load_dwordx4 v11, s[20:23], s65 offen offset:1024 sc1 lds
v_mfma_f32_16x16x32_bf16 v[224:227], a[88:91], v[92:95], v[224:227]
ds_read_b128 v[88:91], v53 offset:30720
v_mfma_f32_16x16x32_bf16 v[228:231], a[92:95], v[92:95], v[228:231]
s_waitcnt lgkmcnt(5)
v_mfma_f32_16x16x32_bf16 v[208:211], a[96:99], v[64:67], v[208:211]
ds_read_b128 v[92:95], v53 offset:31744
v_mfma_f32_16x16x32_bf16 v[212:215], a[100:103], v[64:67], v[212:215]
buffer_load_dwordx4 v11, s[20:23], s65 offen offset:2048 sc1 lds
v_mfma_f32_16x16x32_bf16 v[208:211], a[104:107], v[68:71], v[208:211]
ds_read_b128 v[64:67], v53 offset:32768
v_mfma_f32_16x16x32_bf16 v[212:215], a[108:111], v[68:71], v[212:215]
s_waitcnt lgkmcnt(5)
v_mfma_f32_16x16x32_bf16 v[208:211], a[112:115], v[72:75], v[208:211]
ds_read_b128 v[68:71], v53 offset:33792
v_mfma_f32_16x16x32_bf16 v[212:215], a[116:119], v[72:75], v[212:215]
v_mfma_f32_16x16x32_bf16 v[208:211], a[120:123], v[76:79], v[208:211]
ds_read_b128 v[72:75], v53 offset:34816
v_mfma_f32_16x16x32_bf16 v[212:215], a[124:127], v[76:79], v[212:215]
s_waitcnt lgkmcnt(5)
v_mfma_f32_16x16x32_bf16 v[216:219], a[96:99], v[80:83], v[216:219]
ds_read_b128 v[76:79], v53 offset:35840
v_mfma_f32_16x16x32_bf16 v[220:223], a[100:103], v[80:83], v[220:223]
s_waitcnt vmcnt(7)
s_barrier
v_mfma_f32_16x16x32_bf16 v[216:219], a[104:107], v[84:87], v[216:219]
ds_read_b128 v[80:83], v53 offset:36864
v_mfma_f32_16x16x32_bf16 v[220:223], a[108:111], v[84:87], v[220:223]
s_add_u32 m0, s71, 143360
s_waitcnt lgkmcnt(5)
v_mfma_f32_16x16x32_bf16 v[216:219], a[112:115], v[88:91], v[216:219]
ds_read_b128 v[84:87], v53 offset:37888
v_mfma_f32_16x16x32_bf16 v[220:223], a[116:119], v[88:91], v[220:223]
v_mfma_f32_16x16x32_bf16 v[216:219], a[120:123], v[92:95], v[216:219]
ds_read_b128 v[88:91], v53 offset:38912
v_mfma_f32_16x16x32_bf16 v[220:223], a[124:127], v[92:95], v[220:223]
buffer_load_dwordx4 v11, s[20:23], s66 offen offset:0 sc1 lds
s_waitcnt lgkmcnt(5)
v_mfma_f32_16x16x32_bf16 v[224:227], a[96:99], v[64:67], v[224:227]
ds_read_b128 v[92:95], v53 offset:39936
v_mfma_f32_16x16x32_bf16 v[228:231], a[100:103], v[64:67], v[228:231]
v_mfma_f32_16x16x32_bf16 v[224:227], a[104:107], v[68:71], v[224:227]
ds_read_b128 v[64:67], v53 offset:40960
v_mfma_f32_16x16x32_bf16 v[228:231], a[108:111], v[68:71], v[228:231]
s_waitcnt lgkmcnt(5)
v_mfma_f32_16x16x32_bf16 v[224:227], a[112:115], v[72:75], v[224:227]
ds_read_b128 v[68:71], v53 offset:41984
v_mfma_f32_16x16x32_bf16 v[228:231], a[116:119], v[72:75], v[228:231]
buffer_load_dwordx4 v11, s[20:23], s66 offen offset:1024 sc1 lds
v_mfma_f32_16x16x32_bf16 v[224:227], a[120:123], v[76:79], v[224:227]
ds_read_b128 v[72:75], v53 offset:43008
v_mfma_f32_16x16x32_bf16 v[228:231], a[124:127], v[76:79], v[228:231]
s_waitcnt lgkmcnt(5)
v_mfma_f32_16x16x32_bf16 v[208:211], a[128:131], v[80:83], v[208:211]
ds_read_b128 v[76:79], v53 offset:44032
v_mfma_f32_16x16x32_bf16 v[212:215], a[132:135], v[80:83], v[212:215]
v_mfma_f32_16x16x32_bf16 v[208:211], a[136:139], v[84:87], v[208:211]
ds_read_b128 v[80:83], v53 offset:45056
v_mfma_f32_16x16x32_bf16 v[212:215], a[140:143], v[84:87], v[212:215]
buffer_load_dwordx4 v11, s[20:23], s66 offen offset:2048 sc1 lds
s_waitcnt lgkmcnt(5)
v_mfma_f32_16x16x32_bf16 v[208:211], a[144:147], v[88:91], v[208:211]
ds_read_b128 v[84:87], v53 offset:46080
v_mfma_f32_16x16x32_bf16 v[212:215], a[148:151], v[88:91], v[212:215]
v_mfma_f32_16x16x32_bf16 v[208:211], a[152:155], v[92:95], v[208:211]
ds_read_b128 v[88:91], v53 offset:47104
v_mfma_f32_16x16x32_bf16 v[212:215], a[156:159], v[92:95], v[212:215]
s_waitcnt lgkmcnt(5)
v_mfma_f32_16x16x32_bf16 v[216:219], a[128:131], v[64:67], v[216:219]
ds_read_b128 v[92:95], v53 offset:48128
v_mfma_f32_16x16x32_bf16 v[220:223], a[132:135], v[64:67], v[220:223]
s_add_u32 m0, s71, 49152
v_mfma_f32_16x16x32_bf16 v[216:219], a[136:139], v[68:71], v[216:219]
ds_read_b128 v[64:67], v55 offset:0
v_mfma_f32_16x16x32_bf16 v[220:223], a[140:143], v[68:71], v[220:223]
s_waitcnt lgkmcnt(5)
v_mfma_f32_16x16x32_bf16 v[216:219], a[144:147], v[72:75], v[216:219]
ds_read_b128 v[68:71], v55 offset:1024
v_mfma_f32_16x16x32_bf16 v[220:223], a[148:151], v[72:75], v[220:223]
buffer_load_dwordx4 v11, s[20:23], s67 offen offset:0 sc1 lds
v_mfma_f32_16x16x32_bf16 v[216:219], a[152:155], v[76:79], v[216:219]
ds_read_b128 v[72:75], v55 offset:2048
v_mfma_f32_16x16x32_bf16 v[220:223], a[156:159], v[76:79], v[220:223]
s_waitcnt lgkmcnt(5)
v_mfma_f32_16x16x32_bf16 v[224:227], a[128:131], v[80:83], v[224:227]
ds_read_b128 v[76:79], v55 offset:3072
v_mfma_f32_16x16x32_bf16 v[228:231], a[132:135], v[80:83], v[228:231]
v_mfma_f32_16x16x32_bf16 v[224:227], a[136:139], v[84:87], v[224:227]
ds_read_b128 v[80:83], v55 offset:4096
v_mfma_f32_16x16x32_bf16 v[228:231], a[140:143], v[84:87], v[228:231]
buffer_load_dwordx4 v11, s[20:23], s67 offen offset:1024 sc1 lds
s_waitcnt lgkmcnt(5)
v_mfma_f32_16x16x32_bf16 v[224:227], a[144:147], v[88:91], v[224:227]
ds_read_b128 v[84:87], v55 offset:5120
v_mfma_f32_16x16x32_bf16 v[228:231], a[148:151], v[88:91], v[228:231]
v_mfma_f32_16x16x32_bf16 v[224:227], a[152:155], v[92:95], v[224:227]
ds_read_b128 v[88:91], v55 offset:6144
v_mfma_f32_16x16x32_bf16 v[228:231], a[156:159], v[92:95], v[228:231]
s_waitcnt lgkmcnt(5)
v_mfma_f32_16x16x32_bf16 v[208:211], a[160:163], v[64:67], v[208:211]
ds_read_b128 v[92:95], v55 offset:7168
v_mfma_f32_16x16x32_bf16 v[212:215], a[164:167], v[64:67], v[212:215]
buffer_load_dwordx4 v11, s[20:23], s67 offen offset:2048 sc1 lds
v_mfma_f32_16x16x32_bf16 v[208:211], a[168:171], v[68:71], v[208:211]
ds_read_b128 v[64:67], v55 offset:8192
v_mfma_f32_16x16x32_bf16 v[212:215], a[172:175], v[68:71], v[212:215]
s_waitcnt lgkmcnt(5)
v_mfma_f32_16x16x32_bf16 v[208:211], a[176:179], v[72:75], v[208:211]
ds_read_b128 v[68:71], v55 offset:9216
v_mfma_f32_16x16x32_bf16 v[212:215], a[180:183], v[72:75], v[212:215]
v_mfma_f32_16x16x32_bf16 v[208:211], a[184:187], v[76:79], v[208:211]
ds_read_b128 v[72:75], v55 offset:10240
v_mfma_f32_16x16x32_bf16 v[212:215], a[188:191], v[76:79], v[212:215]
s_waitcnt lgkmcnt(5)
v_mfma_f32_16x16x32_bf16 v[216:219], a[160:163], v[80:83], v[216:219]
ds_read_b128 v[76:79], v55 offset:11264
v_mfma_f32_16x16x32_bf16 v[220:223], a[164:167], v[80:83], v[220:223]
s_waitcnt vmcnt(6)
s_barrier
v_mfma_f32_16x16x32_bf16 v[216:219], a[168:171], v[84:87], v[216:219]
ds_read_b128 v[80:83], v55 offset:12288
v_mfma_f32_16x16x32_bf16 v[220:223], a[172:175], v[84:87], v[220:223]
s_add_u32 m0, s71, 61440
s_waitcnt lgkmcnt(5)
v_mfma_f32_16x16x32_bf16 v[216:219], a[176:179], v[88:91], v[216:219]
ds_read_b128 v[84:87], v55 offset:13312
v_mfma_f32_16x16x32_bf16 v[220:223], a[180:183], v[88:91], v[220:223]
v_mfma_f32_16x16x32_bf16 v[216:219], a[184:187], v[92:95], v[216:219]
ds_read_b128 v[88:91], v55 offset:14336
v_mfma_f32_16x16x32_bf16 v[220:223], a[188:191], v[92:95], v[220:223]
buffer_load_dwordx4 v11, s[20:23], s68 offen offset:0 sc1 lds
s_waitcnt lgkmcnt(5)
v_mfma_f32_16x16x32_bf16 v[224:227], a[160:163], v[64:67], v[224:227]
ds_read_b128 v[92:95], v55 offset:15360
v_mfma_f32_16x16x32_bf16 v[228:231], a[164:167], v[64:67], v[228:231]
v_mfma_f32_16x16x32_bf16 v[224:227], a[168:171], v[68:71], v[224:227]
ds_read_b128 v[64:67], v55 offset:16384
v_mfma_f32_16x16x32_bf16 v[228:231], a[172:175], v[68:71], v[228:231]
s_waitcnt lgkmcnt(5)
v_mfma_f32_16x16x32_bf16 v[224:227], a[176:179], v[72:75], v[224:227]
ds_read_b128 v[68:71], v55 offset:17408
v_mfma_f32_16x16x32_bf16 v[228:231], a[180:183], v[72:75], v[228:231]
buffer_load_dwordx4 v11, s[20:23], s68 offen offset:1024 sc1 lds
v_mfma_f32_16x16x32_bf16 v[224:227], a[184:187], v[76:79], v[224:227]
ds_read_b128 v[72:75], v55 offset:18432
v_mfma_f32_16x16x32_bf16 v[228:231], a[188:191], v[76:79], v[228:231]
s_waitcnt lgkmcnt(5)
v_mfma_f32_16x16x32_bf16 v[232:235], a[224:227], v[80:83], v[232:235]
ds_read_b128 v[76:79], v55 offset:19456
v_mfma_f32_16x16x32_bf16 v[236:239], a[228:231], v[80:83], v[236:239]
v_mfma_f32_16x16x32_bf16 v[232:235], a[232:235], v[84:87], v[232:235]
ds_read_b128 v[80:83], v55 offset:20480
v_mfma_f32_16x16x32_bf16 v[236:239], a[236:239], v[84:87], v[236:239]
buffer_load_dwordx4 v11, s[20:23], s68 offen offset:2048 sc1 lds
s_waitcnt lgkmcnt(5)
v_mfma_f32_16x16x32_bf16 v[232:235], a[240:243], v[88:91], v[232:235]
ds_read_b128 v[84:87], v55 offset:21504
v_mfma_f32_16x16x32_bf16 v[236:239], a[244:247], v[88:91], v[236:239]
v_mfma_f32_16x16x32_bf16 v[232:235], a[248:251], v[92:95], v[232:235]
ds_read_b128 v[88:91], v55 offset:22528
v_mfma_f32_16x16x32_bf16 v[236:239], a[252:255], v[92:95], v[236:239]
s_waitcnt lgkmcnt(5)
v_mfma_f32_16x16x32_bf16 v[240:243], a[224:227], v[64:67], v[240:243]
ds_read_b128 v[92:95], v55 offset:23552
v_mfma_f32_16x16x32_bf16 v[244:247], a[228:231], v[64:67], v[244:247]
s_add_u32 m0, s71, 73728
v_cvt_pk_bf16_f32 v136, v208, v209
v_mfma_f32_16x16x32_bf16 v[240:243], a[232:235], v[68:71], v[240:243]
ds_read_b128 v[64:67], v55 offset:24576
v_mfma_f32_16x16x32_bf16 v[244:247], a[236:239], v[68:71], v[244:247]
v_cvt_pk_bf16_f32 v137, v210, v211
v_cvt_pk_bf16_f32 v138, v212, v213
s_waitcnt lgkmcnt(5)
v_mfma_f32_16x16x32_bf16 v[240:243], a[240:243], v[72:75], v[240:243]
ds_read_b128 v[68:71], v55 offset:25600
v_mfma_f32_16x16x32_bf16 v[244:247], a[244:247], v[72:75], v[244:247]
buffer_load_dwordx4 v11, s[20:23], s69 offen offset:0 sc1 lds
v_cvt_pk_bf16_f32 v139, v214, v215
v_mfma_f32_16x16x32_bf16 v[240:243], a[248:251], v[76:79], v[240:243]
ds_read_b128 v[72:75], v55 offset:26624
v_mfma_f32_16x16x32_bf16 v[244:247], a[252:255], v[76:79], v[244:247]
s_add_u32 s35, s74, 24576
buffer_store_dwordx4 v[136:139], v52, s[20:23], s35 offen sc1
v_cvt_pk_bf16_f32 v140, v216, v217
s_waitcnt lgkmcnt(5)
v_mfma_f32_16x16x32_bf16 v[248:251], a[224:227], v[80:83], v[248:251]
ds_read_b128 v[76:79], v55 offset:27648
v_mfma_f32_16x16x32_bf16 v[252:255], a[228:231], v[80:83], v[252:255]
v_cvt_pk_bf16_f32 v141, v218, v219
v_cvt_pk_bf16_f32 v142, v220, v221
v_mfma_f32_16x16x32_bf16 v[248:251], a[232:235], v[84:87], v[248:251]
ds_read_b128 v[80:83], v55 offset:28672
v_mfma_f32_16x16x32_bf16 v[252:255], a[236:239], v[84:87], v[252:255]
buffer_load_dwordx4 v11, s[20:23], s69 offen offset:1024 sc1 lds
v_cvt_pk_bf16_f32 v143, v222, v223
s_waitcnt lgkmcnt(5)
v_mfma_f32_16x16x32_bf16 v[248:251], a[240:243], v[88:91], v[248:251]
ds_read_b128 v[84:87], v55 offset:29696
v_mfma_f32_16x16x32_bf16 v[252:255], a[244:247], v[88:91], v[252:255]
s_add_u32 s35, s74, 28672
buffer_store_dwordx4 v[140:143], v52, s[20:23], s35 offen sc1
v_cvt_pk_bf16_f32 v136, v224, v225
v_mfma_f32_16x16x32_bf16 v[248:251], a[248:251], v[92:95], v[248:251]
ds_read_b128 v[88:91], v55 offset:30720
v_mfma_f32_16x16x32_bf16 v[252:255], a[252:255], v[92:95], v[252:255]
v_cvt_pk_bf16_f32 v137, v226, v227
s_waitcnt lgkmcnt(5)
v_mfma_f32_16x16x32_bf16 v[232:235], a[0:3], v[64:67], v[232:235]
ds_read_b128 v[92:95], v55 offset:31744
v_mfma_f32_16x16x32_bf16 v[236:239], a[4:7], v[64:67], v[236:239]
buffer_load_dwordx4 v11, s[20:23], s69 offen offset:2048 sc1 lds
v_cvt_pk_bf16_f32 v138, v228, v229
v_cvt_pk_bf16_f32 v139, v230, v231
v_mfma_f32_16x16x32_bf16 v[232:235], a[8:11], v[68:71], v[232:235]
ds_read_b128 v[64:67], v55 offset:32768
v_mfma_f32_16x16x32_bf16 v[236:239], a[12:15], v[68:71], v[236:239]
s_add_u32 s35, s74, 32768
buffer_store_dwordx4 v[136:139], v52, s[20:23], s35 offen sc1
s_waitcnt lgkmcnt(5)
v_mfma_f32_16x16x32_bf16 v[232:235], a[16:19], v[72:75], v[232:235]
ds_read_b128 v[68:71], v55 offset:33792
v_mfma_f32_16x16x32_bf16 v[236:239], a[20:23], v[72:75], v[236:239]
v_mfma_f32_16x16x32_bf16 v[232:235], a[24:27], v[76:79], v[232:235]
ds_read_b128 v[72:75], v55 offset:34816
v_mfma_f32_16x16x32_bf16 v[236:239], a[28:31], v[76:79], v[236:239]
s_waitcnt lgkmcnt(5)
v_mfma_f32_16x16x32_bf16 v[240:243], a[0:3], v[80:83], v[240:243]
ds_read_b128 v[76:79], v55 offset:35840
v_mfma_f32_16x16x32_bf16 v[244:247], a[4:7], v[80:83], v[244:247]
s_waitcnt vmcnt(9)
s_barrier
v_mfma_f32_16x16x32_bf16 v[240:243], a[8:11], v[84:87], v[240:243]
ds_read_b128 v[80:83], v55 offset:36864
v_mfma_f32_16x16x32_bf16 v[244:247], a[12:15], v[84:87], v[244:247]
s_add_u32 m0, s71, 86016
s_waitcnt lgkmcnt(5)
v_mfma_f32_16x16x32_bf16 v[240:243], a[16:19], v[88:91], v[240:243]
ds_read_b128 v[84:87], v55 offset:37888
v_mfma_f32_16x16x32_bf16 v[244:247], a[20:23], v[88:91], v[244:247]
v_mfma_f32_16x16x32_bf16 v[240:243], a[24:27], v[92:95], v[240:243]
ds_read_b128 v[88:91], v55 offset:38912
v_mfma_f32_16x16x32_bf16 v[244:247], a[28:31], v[92:95], v[244:247]
s_waitcnt lgkmcnt(5)
v_mfma_f32_16x16x32_bf16 v[248:251], a[0:3], v[64:67], v[248:251]
ds_read_b128 v[92:95], v55 offset:39936
v_mfma_f32_16x16x32_bf16 v[252:255], a[4:7], v[64:67], v[252:255]
v_mfma_f32_16x16x32_bf16 v[248:251], a[8:11], v[68:71], v[248:251]
ds_read_b128 v[64:67], v55 offset:40960
v_mfma_f32_16x16x32_bf16 v[252:255], a[12:15], v[68:71], v[252:255]
s_waitcnt lgkmcnt(5)
v_mfma_f32_16x16x32_bf16 v[248:251], a[16:19], v[72:75], v[248:251]
ds_read_b128 v[68:71], v55 offset:41984
v_mfma_f32_16x16x32_bf16 v[252:255], a[20:23], v[72:75], v[252:255]
buffer_load_dwordx4 v11, s[20:23], s70 offen offset:0 sc1 lds
v_mfma_f32_16x16x32_bf16 v[248:251], a[24:27], v[76:79], v[248:251]
ds_read_b128 v[72:75], v55 offset:43008
v_mfma_f32_16x16x32_bf16 v[252:255], a[28:31], v[76:79], v[252:255]
s_waitcnt lgkmcnt(5)
v_mfma_f32_16x16x32_bf16 v[232:235], a[32:35], v[80:83], v[232:235]
ds_read_b128 v[76:79], v55 offset:44032
v_mfma_f32_16x16x32_bf16 v[236:239], a[36:39], v[80:83], v[236:239]
v_mfma_f32_16x16x32_bf16 v[232:235], a[40:43], v[84:87], v[232:235]
ds_read_b128 v[80:83], v55 offset:45056
v_mfma_f32_16x16x32_bf16 v[236:239], a[44:47], v[84:87], v[236:239]
s_waitcnt lgkmcnt(5)
v_mfma_f32_16x16x32_bf16 v[232:235], a[48:51], v[88:91], v[232:235]
ds_read_b128 v[84:87], v55 offset:46080
v_mfma_f32_16x16x32_bf16 v[236:239], a[52:55], v[88:91], v[236:239]
v_mfma_f32_16x16x32_bf16 v[232:235], a[56:59], v[92:95], v[232:235]
ds_read_b128 v[88:91], v55 offset:47104
v_mfma_f32_16x16x32_bf16 v[236:239], a[60:63], v[92:95], v[236:239]
s_waitcnt lgkmcnt(5)
v_mfma_f32_16x16x32_bf16 v[240:243], a[32:35], v[64:67], v[240:243]
ds_read_b128 v[92:95], v55 offset:48128
v_mfma_f32_16x16x32_bf16 v[244:247], a[36:39], v[64:67], v[244:247]
buffer_load_dwordx4 v11, s[20:23], s70 offen offset:1024 sc1 lds
v_mfma_f32_16x16x32_bf16 v[240:243], a[40:43], v[68:71], v[240:243]
ds_read_b128 v[64:67], v53 offset:0
v_mfma_f32_16x16x32_bf16 v[244:247], a[44:47], v[68:71], v[244:247]
s_waitcnt lgkmcnt(5)
v_mfma_f32_16x16x32_bf16 v[240:243], a[48:51], v[72:75], v[240:243]
ds_read_b128 v[68:71], v53 offset:1024
v_mfma_f32_16x16x32_bf16 v[244:247], a[52:55], v[72:75], v[244:247]
v_mfma_f32_16x16x32_bf16 v[240:243], a[56:59], v[76:79], v[240:243]
ds_read_b128 v[72:75], v53 offset:2048
v_mfma_f32_16x16x32_bf16 v[244:247], a[60:63], v[76:79], v[244:247]
s_waitcnt vmcnt(2)
s_mov_b64 exec, 1
v_mov_b32 v62, 0
buffer_store_dwordx2 v[60:61], v62, s[20:23], s77 offen sc1
s_mov_b64 exec, -1
s_waitcnt lgkmcnt(5)
v_mfma_f32_16x16x32_bf16 v[248:251], a[32:35], v[80:83], v[248:251]
ds_read_b128 v[76:79], v53 offset:3072
v_mfma_f32_16x16x32_bf16 v[252:255], a[36:39], v[80:83], v[252:255]
v_mfma_f32_16x16x32_bf16 v[248:251], a[40:43], v[84:87], v[248:251]
ds_read_b128 v[80:83], v53 offset:4096
v_mfma_f32_16x16x32_bf16 v[252:255], a[44:47], v[84:87], v[252:255]
buffer_load_dwordx4 v11, s[20:23], s70 offen offset:2048 sc1 lds
s_waitcnt lgkmcnt(5)
v_mfma_f32_16x16x32_bf16 v[248:251], a[48:51], v[88:91], v[248:251]
ds_read_b128 v[84:87], v53 offset:5120
v_mfma_f32_16x16x32_bf16 v[252:255], a[52:55], v[88:91], v[252:255]
v_mfma_f32_16x16x32_bf16 v[248:251], a[56:59], v[92:95], v[248:251]
ds_read_b128 v[88:91], v53 offset:6144
v_mfma_f32_16x16x32_bf16 v[252:255], a[60:63], v[92:95], v[252:255]
s_waitcnt lgkmcnt(5)
v_mfma_f32_16x16x32_bf16 v[232:235], a[64:67], v[64:67], v[232:235]
ds_read_b128 v[92:95], v53 offset:7168
v_mfma_f32_16x16x32_bf16 v[236:239], a[68:71], v[64:67], v[236:239]
v_mfma_f32_16x16x32_bf16 v[232:235], a[72:75], v[68:71], v[232:235]
ds_read_b128 v[64:67], v53 offset:8192
v_mfma_f32_16x16x32_bf16 v[236:239], a[76:79], v[68:71], v[236:239]
s_waitcnt lgkmcnt(5)
v_mfma_f32_16x16x32_bf16 v[232:235], a[80:83], v[72:75], v[232:235]
ds_read_b128 v[68:71], v53 offset:9216
v_mfma_f32_16x16x32_bf16 v[236:239], a[84:87], v[72:75], v[236:239]
v_mfma_f32_16x16x32_bf16 v[232:235], a[88:91], v[76:79], v[232:235]
ds_read_b128 v[72:75], v53 offset:10240
v_mfma_f32_16x16x32_bf16 v[236:239], a[92:95], v[76:79], v[236:239]
s_waitcnt lgkmcnt(5)
v_mfma_f32_16x16x32_bf16 v[240:243], a[64:67], v[80:83], v[240:243]
ds_read_b128 v[76:79], v53 offset:11264
v_mfma_f32_16x16x32_bf16 v[244:247], a[68:71], v[80:83], v[244:247]
s_barrier
v_mfma_f32_16x16x32_bf16 v[240:243], a[72:75], v[84:87], v[240:243]
ds_read_b128 v[80:83], v53 offset:12288
v_mfma_f32_16x16x32_bf16 v[244:247], a[76:79], v[84:87], v[244:247]
s_waitcnt lgkmcnt(5)
v_mfma_f32_16x16x32_bf16 v[240:243], a[80:83], v[88:91], v[240:243]
ds_read_b128 v[84:87], v53 offset:13312
v_mfma_f32_16x16x32_bf16 v[244:247], a[84:87], v[88:91], v[244:247]
v_mfma_f32_16x16x32_bf16 v[240:243], a[88:91], v[92:95], v[240:243]
ds_read_b128 v[88:91], v53 offset:14336
v_mfma_f32_16x16x32_bf16 v[244:247], a[92:95], v[92:95], v[244:247]
s_waitcnt lgkmcnt(5)
v_mfma_f32_16x16x32_bf16 v[248:251], a[64:67], v[64:67], v[248:251]
ds_read_b128 v[92:95], v53 offset:15360
v_mfma_f32_16x16x32_bf16 v[252:255], a[68:71], v[64:67], v[252:255]
v_mfma_f32_16x16x32_bf16 v[248:251], a[72:75], v[68:71], v[248:251]
ds_read_b128 v[64:67], v53 offset:16384
v_mfma_f32_16x16x32_bf16 v[252:255], a[76:79], v[68:71], v[252:255]
buffer_load_dwordx2 v[62:63], v157, s[20:23], 0 offen sc1
s_waitcnt lgkmcnt(5)
v_mfma_f32_16x16x32_bf16 v[248:251], a[80:83], v[72:75], v[248:251]
ds_read_b128 v[68:71], v53 offset:17408
v_mfma_f32_16x16x32_bf16 v[252:255], a[84:87], v[72:75], v[252:255]
v_mfma_f32_16x16x32_bf16 v[248:251], a[88:91], v[76:79], v[248:251]
ds_read_b128 v[72:75], v53 offset:18432
v_mfma_f32_16x16x32_bf16 v[252:255], a[92:95], v[76:79], v[252:255]
s_waitcnt lgkmcnt(5)
v_mfma_f32_16x16x32_bf16 v[232:235], a[96:99], v[80:83], v[232:235]
ds_read_b128 v[76:79], v53 offset:19456
v_mfma_f32_16x16x32_bf16 v[236:239], a[100:103], v[80:83], v[236:239]
v_mfma_f32_16x16x32_bf16 v[232:235], a[104:107], v[84:87], v[232:235]
ds_read_b128 v[80:83], v53 offset:20480
v_mfma_f32_16x16x32_bf16 v[236:239], a[108:111], v[84:87], v[236:239]
s_waitcnt lgkmcnt(5)
v_mfma_f32_16x16x32_bf16 v[232:235], a[112:115], v[88:91], v[232:235]
ds_read_b128 v[84:87], v53 offset:21504
v_mfma_f32_16x16x32_bf16 v[236:239], a[116:119], v[88:91], v[236:239]
v_mfma_f32_16x16x32_bf16 v[232:235], a[120:123], v[92:95], v[232:235]
ds_read_b128 v[88:91], v53 offset:22528
v_mfma_f32_16x16x32_bf16 v[236:239], a[124:127], v[92:95], v[236:239]
s_waitcnt lgkmcnt(5)
v_mfma_f32_16x16x32_bf16 v[240:243], a[96:99], v[64:67], v[240:243]
ds_read_b128 v[92:95], v53 offset:23552
v_mfma_f32_16x16x32_bf16 v[244:247], a[100:103], v[64:67], v[244:247]
v_mfma_f32_16x16x32_bf16 v[240:243], a[104:107], v[68:71], v[240:243]
ds_read_b128 v[64:67], v53 offset:24576
v_mfma_f32_16x16x32_bf16 v[244:247], a[108:111], v[68:71], v[244:247]
s_waitcnt vmcnt(0)
v_cmp_eq_u64 vcc, v[62:63], v[60:61]
s_nop 3
s_and_b32 s54, vcc_lo, 7
s_cmp_eq_u32 s54, 7
s_cbranch_scc0 L_slowg
L_backg:
s_waitcnt lgkmcnt(5)
v_mfma_f32_16x16x32_bf16 v[240:243], a[112:115], v[72:75], v[240:243]
ds_read_b128 v[68:71], v53 offset:25600
v_mfma_f32_16x16x32_bf16 v[244:247], a[116:119], v[72:75], v[244:247]
s_add_u32 s35, s36, 0
buffer_load_dwordx4 v[100:103], v52, s[20:23], s35 offen sc1
v_mfma_f32_16x16x32_bf16 v[240:243], a[120:123], v[76:79], v[240:243]
ds_read_b128 v[72:75], v53 offset:26624
v_mfma_f32_16x16x32_bf16 v[244:247], a[124:127], v[76:79], v[244:247]
s_waitcnt lgkmcnt(5)
v_mfma_f32_16x16x32_bf16 v[248:251], a[96:99], v[80:83], v[248:251]
ds_read_b128 v[76:79], v53 offset:27648
v_mfma_f32_16x16x32_bf16 v[252:255], a[100:103], v[80:83], v[252:255]
s_add_u32 s35, s36, 4096
buffer_load_dwordx4 v[104:107], v52, s[20:23], s35 offen sc1
v_mfma_f32_16x16x32_bf16 v[248:251], a[104:107], v[84:87], v[248:251]
ds_read_b128 v[80:83], v53 offset:28672
v_mfma_f32_16x16x32_bf16 v[252:255], a[108:111], v[84:87], v[252:255]
s_waitcnt lgkmcnt(5)
v_mfma_f32_16x16x32_bf16 v[248:251], a[112:115], v[88:91], v[248:251]
ds_read_b128 v[84:87], v53 offset:29696
v_mfma_f32_16x16x32_bf16 v[252:255], a[116:119], v[88:91], v[252:255]
s_add_u32 s35, s36, 8192
buffer_load_dwordx4 v[108:111], v52, s[20:23], s35 offen sc1
v_mfma_f32_16x16x32_bf16 v[248:251], a[120:123], v[92:95], v[248:251]
ds_read_b128 v[88:91], v53 offset:30720
v_mfma_f32_16x16x32_bf16 v[252:255], a[124:127], v[92:95], v[252:255]
s_waitcnt lgkmcnt(5)
v_mfma_f32_16x16x32_bf16 v[232:235], a[128:131], v[64:67], v[232:235]
ds_read_b128 v[92:95], v53 offset:31744
v_mfma_f32_16x16x32_bf16 v[236:239], a[132:135], v[64:67], v[236:239]
s_add_u32 s35, s36, 12288
buffer_load_dwordx4 v[112:115], v52, s[20:23], s35 offen sc1
v_mfma_f32_16x16x32_bf16 v[232:235], a[136:139], v[68:71], v[232:235]
ds_read_b128 v[64:67], v53 offset:32768
v_mfma_f32_16x16x32_bf16 v[236:239], a[140:143], v[68:71], v[236:239]
s_waitcnt lgkmcnt(5)
v_mfma_f32_16x16x32_bf16 v[232:235], a[144:147], v[72:75], v[232:235]
ds_read_b128 v[68:71], v53 offset:33792
v_mfma_f32_16x16x32_bf16 v[236:239], a[148:151], v[72:75], v[236:239]
s_add_u32 s35, s36, 16384
buffer_load_dwordx4 v[116:119], v52, s[20:23], s35 offen sc1
v_mfma_f32_16x16x32_bf16 v[232:235], a[152:155], v[76:79], v[232:235]
ds_read_b128 v[72:75], v53 offset:34816
v_mfma_f32_16x16x32_bf16 v[236:239], a[156:159], v[76:79], v[236:239]
s_waitcnt lgkmcnt(5)
v_mfma_f32_16x16x32_bf16 v[240:243], a[128:131], v[80:83], v[240:243]
ds_read_b128 v[76:79], v53 offset:35840
v_mfma_f32_16x16x32_bf16 v[244:247], a[132:135], v[80:83], v[244:247]
s_barrier
v_mfma_f32_16x16x32_bf16 v[240:243], a[136:139], v[84:87], v[240:243]
ds_read_b128 v[80:83], v53 offset:36864
v_mfma_f32_16x16x32_bf16 v[244:247], a[140:143], v[84:87], v[244:247]
s_add_u32 s35, s36, 20480
buffer_load_dwordx4 v[120:123], v52, s[20:23], s35 offen sc1
s_waitcnt lgkmcnt(5)
v_mfma_f32_16x16x32_bf16 v[240:243], a[144:147], v[88:91], v[240:243]
ds_read_b128 v[84:87], v53 offset:37888
v_mfma_f32_16x16x32_bf16 v[244:247], a[148:151], v[88:91], v[244:247]
s_add_u32 s35, s36, 24576
buffer_load_dwordx4 v[124:127], v52, s[20:23], s35 offen sc1
v_mfma_f32_16x16x32_bf16 v[240:243], a[152:155], v[92:95], v[240:243]
ds_read_b128 v[88:91], v53 offset:38912
v_mfma_f32_16x16x32_bf16 v[244:247], a[156:159], v[92:95], v[244:247]
s_waitcnt lgkmcnt(5)
v_mfma_f32_16x16x32_bf16 v[248:251], a[128:131], v[64:67], v[248:251]
ds_read_b128 v[92:95], v53 offset:39936
v_mfma_f32_16x16x32_bf16 v[252:255], a[132:135], v[64:67], v[252:255]
s_add_u32 s35, s36, 28672
buffer_load_dwordx4 v[128:131], v52, s[20:23], s35 offen sc1
v_mfma_f32_16x16x32_bf16 v[248:251], a[136:139], v[68:71], v[248:251]
ds_read_b128 v[64:67], v53 offset:40960
v_mfma_f32_16x16x32_bf16 v[252:255], a[140:143], v[68:71], v[252:255]
s_waitcnt lgkmcnt(5)
v_mfma_f32_16x16x32_bf16 v[248:251], a[144:147], v[72:75], v[248:251]
ds_read_b128 v[68:71], v53 offset:41984
v_mfma_f32_16x16x32_bf16 v[252:255], a[148:151], v[72:75], v[252:255]
s_add_u32 s35, s36, 32768
buffer_load_dwordx4 v[132:135], v52, s[20:23], s35 offen sc1
v_mfma_f32_16x16x32_bf16 v[248:251], a[152:155], v[76:79], v[248:251]
ds_read_b128 v[72:75], v53 offset:43008
v_mfma_f32_16x16x32_bf16 v[252:255], a[156:159], v[76:79], v[252:255]
s_waitcnt lgkmcnt(5)
v_mfma_f32_16x16x32_bf16 v[232:235], a[160:163], v[80:83], v[232:235]
ds_read_b128 v[76:79], v53 offset:44032
v_mfma_f32_16x16x32_bf16 v[236:239], a[164:167], v[80:83], v[236:239]
v_mfma_f32_16x16x32_bf16 v[232:235], a[168:171], v[84:87], v[232:235]
ds_read_b128 v[80:83], v53 offset:45056
v_mfma_f32_16x16x32_bf16 v[236:239], a[172:175], v[84:87], v[236:239]
s_waitcnt lgkmcnt(5)
v_mfma_f32_16x16x32_bf16 v[232:235], a[176:179], v[88:91], v[232:235]
ds_read_b128 v[84:87], v53 offset:46080
v_mfma_f32_16x16x32_bf16 v[236:239], a[180:183], v[88:91], v[236:239]
v_mfma_f32_16x16x32_bf16 v[232:235], a[184:187], v[92:95], v[232:235]
ds_read_b128 v[88:91], v53 offset:47104
v_mfma_f32_16x16x32_bf16 v[236:239], a[188:191], v[92:95], v[236:239]
s_waitcnt lgkmcnt(5)
v_mfma_f32_16x16x32_bf16 v[240:243], a[160:163], v[64:67], v[240:243]
ds_read_b128 v[92:95], v53 offset:48128
v_mfma_f32_16x16x32_bf16 v[244:247], a[164:167], v[64:67], v[244:247]
v_mfma_f32_16x16x32_bf16 v[240:243], a[168:171], v[68:71], v[240:243]
v_mfma_f32_16x16x32_bf16 v[244:247], a[172:175], v[68:71], v[244:247]
s_waitcnt lgkmcnt(4)
v_mfma_f32_16x16x32_bf16 v[240:243], a[176:179], v[72:75], v[240:243]
v_mfma_f32_16x16x32_bf16 v[244:247], a[180:183], v[72:75], v[244:247]
v_mfma_f32_16x16x32_bf16 v[240:243], a[184:187], v[76:79], v[240:243]
v_mfma_f32_16x16x32_bf16 v[244:247], a[188:191], v[76:79], v[244:247]
s_waitcnt lgkmcnt(2)
v_mfma_f32_16x16x32_bf16 v[248:251], a[160:163], v[80:83], v[248:251]
v_mfma_f32_16x16x32_bf16 v[252:255], a[164:167], v[80:83], v[252:255]
v_mfma_f32_16x16x32_bf16 v[248:251], a[168:171], v[84:87], v[248:251]
v_mfma_f32_16x16x32_bf16 v[252:255], a[172:175], v[84:87], v[252:255]
s_waitcnt lgkmcnt(0)
v_mfma_f32_16x16x32_bf16 v[248:251], a[176:179], v[88:91], v[248:251]
v_mfma_f32_16x16x32_bf16 v[252:255], a[180:183], v[88:91], v[252:255]
v_mfma_f32_16x16x32_bf16 v[248:251], a[184:187], v[92:95], v[248:251]
v_mfma_f32_16x16x32_bf16 v[252:255], a[188:191], v[92:95], v[252:255]
s_waitcnt vmcnt(0)
v_mfma_f32_16x16x32_bf16 v[232:235], v[146:149], v[100:103], v[232:235]
v_mfma_f32_16x16x32_bf16 v[236:239], v[144:147], v[100:103], v[236:239]
v_mfma_f32_16x16x32_bf16 v[232:235], v[146:149], v[112:115], v[232:235]
v_mfma_f32_16x16x32_bf16 v[236:239], v[144:147], v[112:115], v[236:239]
v_mfma_f32_16x16x32_bf16 v[232:235], v[146:149], v[124:127], v[232:235]
v_mfma_f32_16x16x32_bf16 v[236:239], v[144:147], v[124:127], v[236:239]
v_mfma_f32_16x16x32_bf16 v[240:243], v[146:149], v[104:107], v[240:243]
v_mfma_f32_16x16x32_bf16 v[244:247], v[144:147], v[104:107], v[244:247]
v_mfma_f32_16x16x32_bf16 v[240:243], v[146:149], v[116:119], v[240:243]
v_mfma_f32_16x16x32_bf16 v[244:247], v[144:147], v[116:119], v[244:247]
v_mfma_f32_16x16x32_bf16 v[240:243], v[146:149], v[128:131], v[240:243]
v_mfma_f32_16x16x32_bf16 v[244:247], v[144:147], v[128:131], v[244:247]
v_mfma_f32_16x16x32_bf16 v[248:251], v[146:149], v[108:111], v[248:251]
v_mfma_f32_16x16x32_bf16 v[252:255], v[144:147], v[108:111], v[252:255]
v_mfma_f32_16x16x32_bf16 v[248:251], v[146:149], v[120:123], v[248:251]
v_mfma_f32_16x16x32_bf16 v[252:255], v[144:147], v[120:123], v[252:255]
v_mfma_f32_16x16x32_bf16 v[248:251], v[146:149], v[132:135], v[248:251]
v_mfma_f32_16x16x32_bf16 v[252:255], v[144:147], v[132:135], v[252:255]
v_cvt_pk_bf16_f32 v64, v232, v233
v_cvt_pk_bf16_f32 v65, v234, v235
v_cvt_pk_bf16_f32 v66, v236, v237
v_cvt_pk_bf16_f32 v67, v238, v239
s_nop 0
v_permlane16_swap_b32 v64, v66
v_permlane16_swap_b32 v65, v67
s_mov_b32 s35, 0
buffer_store_dwordx4 v[64:67], v158, s[44:47], s35 offen
v_cvt_pk_bf16_f32 v68, v240, v241
v_cvt_pk_bf16_f32 v69, v242, v243
v_cvt_pk_bf16_f32 v70, v244, v245
v_cvt_pk_bf16_f32 v71, v246, v247
s_nop 0
v_permlane16_swap_b32 v68, v70
v_permlane16_swap_b32 v69, v71
s_mov_b32 s35, 65536
buffer_store_dwordx4 v[68:71], v158, s[44:47], s35 offen
v_cvt_pk_bf16_f32 v72, v248, v249
v_cvt_pk_bf16_f32 v73, v250, v251
v_cvt_pk_bf16_f32 v74, v252, v253
v_cvt_pk_bf16_f32 v75, v254, v255
s_nop 0
v_permlane16_swap_b32 v72, v74
v_permlane16_swap_b32 v73, v75
s_mov_b32 s35, 131072
buffer_store_dwordx4 v[72:75], v158, s[44:47], s35 offen
L_end:
s_endpgm
L_slow0:
s_mov_b32 s59, 65536
L_poll0:
buffer_load_dwordx2 v[62:63], v154, s[20:23], 0 offen sc1
s_waitcnt vmcnt(0)
v_cmp_eq_u64 vcc, v[62:63], v[60:61]
s_nop 4
s_mov_b32 s54, vcc_lo
s_bitcmp1_b32 s54, 1
s_cbranch_scc1 L_back0
s_sub_u32 s59, s59, 1
s_cmp_lg_u32 s59, 0
s_cbranch_scc1 L_poll0
s_branch L_back0
L_slow1:
s_mov_b32 s59, 65536
L_poll1:
buffer_load_dwordx2 v[62:63], v154, s[20:23], 0 offen sc1
s_waitcnt vmcnt(0)
v_cmp_eq_u64 vcc, v[62:63], v[60:61]
s_nop 4
s_mov_b32 s54, vcc_lo
s_bitcmp1_b32 s54, 9
s_cbranch_scc1 L_back1
s_sub_u32 s59, s59, 1
s_cmp_lg_u32 s59, 0
s_cbranch_scc1 L_poll1
s_branch L_back1
L_slow2:
s_mov_b32 s59, 65536
L_poll2:
buffer_load_dwordx2 v[62:63], v154, s[20:23], 0 offen sc1
s_waitcnt vmcnt(0)
v_cmp_eq_u64 vcc, v[62:63], v[60:61]
s_nop 4
s_mov_b32 s54, vcc_lo
s_bitcmp1_b32 s54, 2
s_cbranch_scc1 L_back2
s_sub_u32 s59, s59, 1
s_cmp_lg_u32 s59, 0
s_cbranch_scc1 L_poll2
s_branch L_back2
L_slow3:
s_mov_b32 s59, 65536
L_poll3:
buffer_load_dwordx2 v[62:63], v154, s[20:23], 0 offen sc1
s_waitcnt vmcnt(0)
v_cmp_eq_u64 vcc, v[62:63], v[60:61]
s_nop 4
s_mov_b32 s54, vcc_lo
s_bitcmp1_b32 s54, 10
s_cbranch_scc1 L_back3
s_sub_u32 s59, s59, 1
s_cmp_lg_u32 s59, 0
s_cbranch_scc1 L_poll3
s_branch L_back3
L_slow4:
s_mov_b32 s59, 65536
L_poll4:
buffer_load_dwordx2 v[62:63], v154, s[20:23], 0 offen sc1
s_waitcnt vmcnt(0)
v_cmp_eq_u64 vcc, v[62:63], v[60:61]
s_nop 4
s_mov_b32 s54, vcc_lo
s_bitcmp1_b32 s54, 3
s_cbranch_scc1 L_back4
s_sub_u32 s59, s59, 1
s_cmp_lg_u32 s59, 0
s_cbranch_scc1 L_poll4
s_branch L_back4
L_slow5:
s_mov_b32 s59, 65536
L_poll5:
buffer_load_dwordx2 v[62:63], v154, s[20:23], 0 offen sc1
s_waitcnt vmcnt(0)
v_cmp_eq_u64 vcc, v[62:63], v[60:61]
s_nop 4
s_mov_b32 s54, vcc_lo
s_bitcmp1_b32 s54, 11
s_cbranch_scc1 L_back5
s_sub_u32 s59, s59, 1
s_cmp_lg_u32 s59, 0
s_cbranch_scc1 L_poll5
s_branch L_back5
L_slow6:
s_mov_b32 s59, 65536
L_poll6:
buffer_load_dwordx2 v[62:63], v154, s[20:23], 0 offen sc1
s_waitcnt vmcnt(0)
v_cmp_eq_u64 vcc, v[62:63], v[60:61]
s_nop 4
s_mov_b32 s54, vcc_lo
s_bitcmp1_b32 s54, 4
s_cbranch_scc1 L_back6
s_sub_u32 s59, s59, 1
s_cmp_lg_u32 s59, 0
s_cbranch_scc1 L_poll6
s_branch L_back6
L_slow7:
s_mov_b32 s59, 65536
L_poll7:
buffer_load_dwordx2 v[62:63], v154, s[20:23], 0 offen sc1
s_waitcnt vmcnt(0)
v_cmp_eq_u64 vcc, v[62:63], v[60:61]
s_nop 4
s_mov_b32 s54, vcc_lo
s_bitcmp1_b32 s54, 12
s_cbranch_scc1 L_back7
s_sub_u32 s59, s59, 1
s_cmp_lg_u32 s59, 0
s_cbranch_scc1 L_poll7
s_branch L_back7
L_slow8:
s_mov_b32 s59, 65536
L_poll8:
buffer_load_dwordx2 v[62:63], v154, s[20:23], 0 offen sc1
s_waitcnt vmcnt(0)
v_cmp_eq_u64 vcc, v[62:63], v[60:61]
s_nop 4
s_mov_b32 s54, vcc_lo
s_bitcmp1_b32 s54, 5
s_cbranch_scc1 L_back8
s_sub_u32 s59, s59, 1
s_cmp_lg_u32 s59, 0
s_cbranch_scc1 L_poll8
s_branch L_back8
L_slow9:
s_mov_b32 s59, 65536
L_poll9:
buffer_load_dwordx2 v[62:63], v154, s[20:23], 0 offen sc1
s_waitcnt vmcnt(0)
v_cmp_eq_u64 vcc, v[62:63], v[60:61]
s_nop 4
s_mov_b32 s54, vcc_lo
s_bitcmp1_b32 s54, 13
s_cbranch_scc1 L_back9
s_sub_u32 s59, s59, 1
s_cmp_lg_u32 s59, 0
s_cbranch_scc1 L_poll9
s_branch L_back9
L_slow10:
s_mov_b32 s59, 65536
L_poll10:
buffer_load_dwordx2 v[62:63], v154, s[20:23], 0 offen sc1
s_waitcnt vmcnt(0)
v_cmp_eq_u64 vcc, v[62:63], v[60:61]
s_nop 4
s_mov_b32 s54, vcc_lo
s_bitcmp1_b32 s54, 6
s_cbranch_scc1 L_back10
s_sub_u32 s59, s59, 1
s_cmp_lg_u32 s59, 0
s_cbranch_scc1 L_poll10
s_branch L_back10
L_slow11:
s_mov_b32 s59, 65536
L_poll11:
buffer_load_dwordx2 v[62:63], v154, s[20:23], 0 offen sc1
s_waitcnt vmcnt(0)
v_cmp_eq_u64 vcc, v[62:63], v[60:61]
s_nop 4
s_mov_b32 s54, vcc_lo
s_bitcmp1_b32 s54, 14
s_cbranch_scc1 L_back11
s_sub_u32 s59, s59, 1
s_cmp_lg_u32 s59, 0
s_cbranch_scc1 L_poll11
s_branch L_back11
L_slow12:
s_mov_b32 s59, 65536
L_poll12:
buffer_load_dwordx2 v[62:63], v154, s[20:23], 0 offen sc1
s_waitcnt vmcnt(0)
v_cmp_eq_u64 vcc, v[62:63], v[60:61]
s_nop 4
s_mov_b32 s54, vcc_lo
s_bitcmp1_b32 s54, 7
s_cbranch_scc1 L_back12
s_sub_u32 s59, s59, 1
s_cmp_lg_u32 s59, 0
s_cbranch_scc1 L_poll12
s_branch L_back12
L_slow13:
s_mov_b32 s59, 65536
L_poll13:
buffer_load_dwordx2 v[62:63], v154, s[20:23], 0 offen sc1
s_waitcnt vmcnt(0)
v_cmp_eq_u64 vcc, v[62:63], v[60:61]
s_nop 4
s_mov_b32 s54, vcc_lo
s_bitcmp1_b32 s54, 15
s_cbranch_scc1 L_back13
s_sub_u32 s59, s59, 1
s_cmp_lg_u32 s59, 0
s_cbranch_scc1 L_poll13
s_branch L_back13
L_slow14:
s_mov_b32 s59, 65536
L_poll14:
buffer_load_dwordx2 v[62:63], v154, s[20:23], 0 offen sc1
s_waitcnt vmcnt(0)
v_cmp_eq_u64 vcc, v[62:63], v[60:61]
s_nop 4
s_mov_b32 s54, vcc_lo
s_and_b32 s3, s54, 0xfe0000
s_cmp_eq_u32 s3, 0xfe0000
s_cbranch_scc1 L_back14
s_sub_u32 s59, s59, 1
s_cmp_lg_u32 s59, 0
s_cbranch_scc1 L_poll14
s_branch L_back14
L_slow15:
s_mov_b32 s59, 65536
L_poll15:
buffer_load_dwordx2 v[62:63], v154, s[20:23], 0 offen sc1
s_waitcnt vmcnt(0)
v_cmp_eq_u64 vcc, v[62:63], v[60:61]
s_nop 4
s_mov_b32 s54, vcc_lo
s_and_b32 s3, s54, 0xfe000000
s_cmp_eq_u32 s3, 0xfe000000
s_cbranch_scc1 L_back15
s_sub_u32 s59, s59, 1
s_cmp_lg_u32 s59, 0
s_cbranch_scc1 L_poll15
s_branch L_back15
L_slowg:
s_mov_b32 s59, 65536
L_pollg:
buffer_load_dwordx2 v[62:63], v157, s[20:23], 0 offen sc1
s_waitcnt vmcnt(0)
v_cmp_eq_u64 vcc, v[62:63], v[60:61]
s_nop 4
s_and_b32 s54, vcc_lo, 7
s_cmp_eq_u32 s54, 7
s_cbranch_scc1 L_backg
s_sub_u32 s59, s59, 1
s_cmp_lg_u32 s59, 0
s_cbranch_scc1 L_pollg
s_branch L_backg
.section .rodata,"a"
.p2align 6
.amdhsa_kernel concat_heads__mha_block_cached__gqa_block_cached__near_ridge_kernel
  .amdhsa_next_free_vgpr 512
  .amdhsa_next_free_sgpr 102
  .amdhsa_accum_offset 256
  .amdhsa_group_segment_fixed_size 0
  .amdhsa_kernarg_size 104
  .amdhsa_user_sgpr_count 2
  .amdhsa_user_sgpr_kernarg_segment_ptr 1
  .amdhsa_system_sgpr_workgroup_id_x 1
  .amdhsa_float_denorm_mode_32 3
.end_amdhsa_kernel
```
